```python
import torch

def _softmax(x, axis=-1):
    return torch.softmax(x, dim=axis)

def _gelu(x):
    return torch.nn.functional.gelu(x, approximate='tanh')

def _silu(x):
    return torch.nn.functional.silu(x)

def _sigmoid(x):
    return torch.sigmoid(x)

def _layernorm(x, axis=-1, eps=1e-05):
    m = x.mean(dim=axis, keepdim=True)
    v = x.var(dim=axis, keepdim=True, unbiased=False)
    return (x - m) / torch.sqrt(v + eps)

def _scatter_add(tgt, idx, src, axis=0):
    return tgt.clone().index_add_(axis, idx, src)

def _segment_sum(src, seg, n):
    out = torch.zeros((n,) + src.shape[1:], dtype=src.dtype)
    return out.index_add_(0, seg, src)

def _pad(x, pw):
    flat = tuple((v for pair in reversed(pw) for v in pair))
    return torch.nn.functional.pad(x, flat)
kernel_name = 'adaLN_cond__sliding_block_cached__swiglu_ffn__decode'

def setup_inputs():

    _w = lambda a: (lambda t: t.to(torch.bfloat16) if t.is_floating_point() else t)(torch.as_tensor(a))

    def _A_setup():
        B, Sq, D = (4, 1, 512)
        Hq, Hkv, Sk, Dh = (32, 8, 8192, 128)
        assert Hq % Hkv == 0, (Hq, Hkv)
        return {'x': _w((lambda *s: torch.randn(*s, dtype=torch.bfloat16) * 0.05)(B, Sq, D)), 'k_cache': _w((lambda *s: torch.randn(*s, dtype=torch.bfloat16) * 3.2)(B, Hkv, Sk, Dh)), 'v_cache': _w((lambda *s: torch.randn(*s, dtype=torch.bfloat16) * 0.4)(B, Hkv, Sk, Dh)), 'wq': _w((lambda *s: torch.randn(*s, dtype=torch.bfloat16) * 3.2)(D, Hq * Dh) * D ** (-0.5)), 'wo': _w((lambda *s: torch.randn(*s, dtype=torch.bfloat16) * 0.4)(Hq * Dh, D) * (Hq * Dh) ** (-0.5))}
    _A_in = _A_setup()

    def _B_setup():
        B, S, D, F = (4, 1, 512, 1792)
        return {'x': _w((lambda *s: torch.randn(*s, dtype=torch.bfloat16) * 0.05)(B, S, D)), 'w_gate': _w((lambda *s: torch.randn(*s, dtype=torch.bfloat16) * 0.05)(D, F)), 'w_up': _w((lambda *s: torch.randn(*s, dtype=torch.bfloat16) * 0.05)(D, F)), 'w_down': _w((lambda *s: torch.randn(*s, dtype=torch.bfloat16) * 0.05)(F, D))}
    _B_in = _B_setup()
    return {'A_x': _A_in['x'], 'A_k_cache': _A_in['k_cache'], 'A_v_cache': _A_in['v_cache'], 'A_wq': _A_in['wq'], 'A_wo': _A_in['wo'], 'B_x': _B_in['x'], 'B_w_gate': _B_in['w_gate'], 'B_w_up': _B_in['w_up'], 'B_w_down': _B_in['w_down'], 'c': _w((lambda *s: torch.randn(*s, dtype=torch.bfloat16) * 0.1)(4, 512) * 8.0), 'w_mod': _w((lambda *s: torch.randn(*s, dtype=torch.bfloat16) * 0.1)(512, 6 * 512) * 512 ** (-0.5) * 8.0)}

def reference(A_x, A_k_cache, A_v_cache, A_wq, A_wo, B_x, B_w_gate, B_w_up, B_w_down, c, w_mod):

    def _A_ref(x, k_cache, v_cache, wq, wo):
        B, Sq, D = x.shape
        Hq, Dh = (32, 128)
        Hkv, Sk = (k_cache.shape[1], k_cache.shape[2])
        W = min(4096, max(256, Sk // 4))
        rep = Hq // Hkv
        q = (lambda x, *d: x.permute(*d))((x @ wq).reshape(B, Sq, Hq, Dh), 0, 2, 1, 3)
        k = (lambda x, n, axis: torch.repeat_interleave(x, n, dim=axis))(k_cache[:, :, Sk - W:, :], rep, axis=1)
        v = (lambda x, n, axis: torch.repeat_interleave(x, n, dim=axis))(v_cache[:, :, Sk - W:, :], rep, axis=1)
        scores = torch.einsum('bhqd,bhkd->bhqk', q, k) * Dh ** (-0.5)
        p = _softmax(scores, axis=-1)
        o = torch.einsum('bhqk,bhkd->bhqd', p, v)
        return (lambda x, *d: x.permute(*d))(o, 0, 2, 1, 3).reshape(B, Sq, Hq * Dh) @ wo

    def _B_ref(x, w_gate, w_up, w_down):
        g = _silu(x @ w_gate)
        u = x @ w_up
        return g * u @ w_down
    x = A_x
    mod = (_silu(c) @ w_mod).reshape(c.shape[0], 6, 1, -1)
    sa, ca, ga, sb, cb, gb = (mod[:, 0].clone(), mod[:, 1].clone(), mod[:, 2].clone(), mod[:, 3].clone(), mod[:, 4].clone(), mod[:, 5].clone())
    h = _layernorm(x, axis=-1) * (1 + ca) + sa
    x = x + ga * _A_ref(h, A_k_cache, A_v_cache, A_wq, A_wo)
    h = _layernorm(x, axis=-1) * (1 + cb) + sb
    x = x + gb * _B_ref(h, B_w_gate, B_w_up, B_w_down)
    return x
```

```asm
; @launch grid=(256,1,1) block=(1024,1,1) lds=163840
.amdgcn_target "amdgcn-amd-amdhsa--gfx950"
.text
.globl adaLN_cond__sliding_block_cached__swiglu_ffn__decode_kernel
.p2align 8
.type adaLN_cond__sliding_block_cached__swiglu_ffn__decode_kernel,@function
adaLN_cond__sliding_block_cached__swiglu_ffn__decode_kernel:
    s_cmp_ge_u32 s2, 256
    s_cbranch_scc1 L_EXIT
    s_load_dwordx16 s[36:51], s[0:1], 0
    s_load_dwordx8 s[52:59], s[0:1], 64
    s_load_dwordx4 s[60:63], s[0:1], 96
    v_lshrrev_b32 v2, 6, v0
    v_and_b32 v1, 63, v0
    v_readfirstlane_b32 s3, v2
    s_and_b32 s5, s2, 7
    s_lshr_b32 s6, s2, 3
    v_lshrrev_b32 v2, 4, v1
    v_and_b32 v3, 15, v1
    s_lshl_b32 s76, s2, 4
    s_add_u32 s76, s76, s3
    s_lshl_b32 s76, s76, 7
    s_add_u32 s76, s76, 2097152
    s_waitcnt lgkmcnt(0)
    s_mov_b32 s8, s62
    s_and_b32 s9, s63, 0xffff
    s_mov_b32 s10, 3145728
    s_mov_b32 s11, 0x20000
    s_cmp_eq_u32 s5, 7
    s_cbranch_scc1 L_T
    s_lshl_b32 s7, s5, 5
    s_add_u32 s7, s7, s6
    s_mul_i32 s64, s6, 37
    s_lshr_b32 s64, s64, 8
    s_mul_i32 s64, s64, 7
    s_sub_u32 s64, s6, s64
    s_add_u32 s65, s5, 7
    s_sub_u32 s65, s65, s64
    s_sub_u32 s66, s65, 7
    s_cmp_ge_u32 s65, 7
    s_cselect_b32 s65, s66, s65
    s_lshl_b32 s80, s6, 1
    s_cmp_eq_u32 s65, 0
    s_cselect_b32 s95, 1, 0
    s_cmp_eq_u32 s65, 3
    s_cselect_b32 s95, 1, s95
    s_cmp_eq_u32 s65, 1
    s_cselect_b32 s79, 1, 0
    s_cmp_eq_u32 s65, 4
    s_cselect_b32 s79, 1, s79
    s_cmp_ge_u32 s65, 3
    s_addc_u32 s80, s80, 0
    s_sub_u32 s66, s6, 4
    s_and_b32 s66, s66, 31
    s_lshl_b32 s66, s66, 1
    s_add_u32 s66, s66, 1
    s_cmp_eq_u32 s65, 4
    s_cselect_b32 s80, s66, s80
    s_lshr_b32 s66, 0x36, s65
    s_and_b32 s81, s66, 1
    s_sub_u32 s93, s65, 1
    s_cmp_ge_u32 s65, 4
    s_cselect_b32 s66, 1, 0
    s_sub_u32 s93, s93, s66
    s_mov_b32 s92, s6
    s_cmp_eq_u32 s95, 1
    s_cselect_b32 s78, 7, 10
    s_add_u32 s66, s64, 3
    s_sub_u32 s67, s66, 7
    s_cmp_ge_u32 s66, 7
    s_cselect_b32 s66, s67, s66
    s_mul_i32 s67, s5, 10
    s_cmp_lt_u32 s64, s5
    s_cselect_b32 s69, 3, 0
    s_sub_u32 s67, s67, s69
    s_cmp_lt_u32 s66, s5
    s_cselect_b32 s69, 3, 0
    s_sub_u32 s67, s67, s69
    s_lshl_b32 s64, s67, 13
    s_lshl_b32 s65, s6, 21
    s_add_u32 s94, s64, s65
    s_add_u32 s94, s94, 1572864
    s_cmp_ge_u32 s3, 12
    s_cbranch_scc1 L_S_STREAM
    s_cmp_ge_u32 s3, 10
    s_cbranch_scc1 L_S_JOB
    s_mov_b32 s12, s38
    s_and_b32 s13, s39, 0xffff
    s_mov_b32 s14, 67108864
    s_mov_b32 s15, 0x20000
    s_lshl_b32 s64, s3, 13
    s_add_u32 s77, s94, s64
    s_mov_b32 s70, 0
    s_cmp_eq_u32 s95, 1
    s_cbranch_scc1 E0_1
    s_cmp_ge_u32 s3, 0
    s_cbranch_scc1 E0_1
    v_lshrrev_b32 v4, 2, v3
    v_and_b32 v5, 1, v1
    v_lshl_add_u32 v4, v4, 1, v5
    v_lshlrev_b32 v4, 8, v4
    v_bfe_u32 v5, v1, 1, 1
    v_lshl_add_u32 v4, v5, 6, v4
    v_lshl_add_u32 v4, v2, 4, v4
    s_add_u32 s64, s77, 4096
    buffer_load_dwordx4 v[32:35], v4, s[12:15], s77 offen offset:0 nt
    buffer_load_dwordx4 v[36:39], v4, s[12:15], s77 offen offset:128 nt
    buffer_load_dwordx4 v[40:43], v4, s[12:15], s77 offen offset:2048 nt
    buffer_load_dwordx4 v[44:47], v4, s[12:15], s77 offen offset:2176 nt
    buffer_load_dwordx4 v[48:51], v4, s[12:15], s64 offen offset:0 nt
    buffer_load_dwordx4 v[52:55], v4, s[12:15], s64 offen offset:128 nt
    buffer_load_dwordx4 v[56:59], v4, s[12:15], s64 offen offset:2048 nt
    buffer_load_dwordx4 v[60:63], v4, s[12:15], s64 offen offset:2176 nt
    s_mov_b32 s70, 1
E0_1:
    s_mov_b32 s100, s70
    s_barrier
    s_cmp_eq_u32 s95, 0
    s_cbranch_scc1 NOQ_2
    s_lshl_b32 s84, s80, 7
    s_lshl_b32 s85, s80, 8
    s_add_u32 s85, s85, 65536
    s_cmp_ge_u32 s3, 8
    s_cbranch_scc1 Q8_3
    s_mov_b32 s20, s42
    s_and_b32 s21, s43, 0xffff
    s_mov_b32 s22, 4194304
    s_mov_b32 s23, 0x20000
    v_lshrrev_b32 v4, 3, v1
    v_mul_u32_u24 v4, 8192, v4
    v_bfe_u32 v5, v1, 1, 2
    v_bfe_u32 v6, v1, 4, 2
    v_xor_b32 v5, v5, v6
    v_lshl_add_u32 v4, v5, 5, v4
    v_and_b32 v5, 1, v1
    v_lshl_add_u32 v4, v5, 4, v4
    s_lshl_b32 s65, s3, 13
    s_mul_i32 s66, s3, 524288
    s_add_u32 s66, s66, s84
    s_mov_b32 m0, s65
    s_add_u32 s65, s65, 1024
    buffer_load_dwordx4 v4, s[20:23], s66 offen nt lds
    s_add_u32 s66, s66, 65536
    s_mov_b32 m0, s65
    s_add_u32 s65, s65, 1024
    buffer_load_dwordx4 v4, s[20:23], s66 offen nt lds
    s_add_u32 s66, s66, 65536
    s_mov_b32 m0, s65
    s_add_u32 s65, s65, 1024
    buffer_load_dwordx4 v4, s[20:23], s66 offen nt lds
    s_add_u32 s66, s66, 65536
    s_mov_b32 m0, s65
    s_add_u32 s65, s65, 1024
    buffer_load_dwordx4 v4, s[20:23], s66 offen nt lds
    s_add_u32 s66, s66, 65536
    s_mov_b32 m0, s65
    s_add_u32 s65, s65, 1024
    buffer_load_dwordx4 v4, s[20:23], s66 offen nt lds
    s_add_u32 s66, s66, 65536
    s_mov_b32 m0, s65
    s_add_u32 s65, s65, 1024
    buffer_load_dwordx4 v4, s[20:23], s66 offen nt lds
    s_add_u32 s66, s66, 65536
    s_mov_b32 m0, s65
    s_add_u32 s65, s65, 1024
    buffer_load_dwordx4 v4, s[20:23], s66 offen nt lds
    s_add_u32 s66, s66, 65536
    s_mov_b32 m0, s65
    s_add_u32 s65, s65, 1024
    buffer_load_dwordx4 v4, s[20:23], s66 offen nt lds
    s_add_u32 s66, s66, 65536
    v_mov_b32 v8, 156428
    v_mov_b32 v9, 1
    s_mov_b64 s[74:75], exec
    s_mov_b64 exec, 1
    ds_add_u32 v8, v9
    s_mov_b64 exec, s[74:75]
    v_mov_b32 v8, 156428
    s_mov_b32 s82, 0
W_5:
    ds_read_b32 v9, v8
    s_waitcnt lgkmcnt(0)
    v_readfirstlane_b32 s71, v9
    s_cmp_ge_u32 s71, 8
    s_cbranch_scc1 WD_6
    s_add_u32 s82, s82, 1
    s_cmp_lt_u32 s82, 4000000
    s_cbranch_scc1 W_5
    s_branch L_END
WD_6:
    s_cmp_ge_u32 s3, 7
    s_cbranch_scc1 Q7_4
    v_lshrrev_b32 v4, 2, v3
    v_and_b32 v5, 1, v1
    v_lshl_add_u32 v4, v4, 1, v5
    v_lshlrev_b32 v4, 8, v4
    v_bfe_u32 v5, v1, 1, 1
    v_lshl_add_u32 v4, v5, 6, v4
    v_lshl_add_u32 v4, v2, 4, v4
    s_add_u32 s64, s77, 4096
    buffer_load_dwordx4 v[32:35], v4, s[12:15], s77 offen offset:0 nt
    buffer_load_dwordx4 v[36:39], v4, s[12:15], s77 offen offset:128 nt
    buffer_load_dwordx4 v[40:43], v4, s[12:15], s77 offen offset:2048 nt
    buffer_load_dwordx4 v[44:47], v4, s[12:15], s77 offen offset:2176 nt
    buffer_load_dwordx4 v[48:51], v4, s[12:15], s64 offen offset:0 nt
    buffer_load_dwordx4 v[52:55], v4, s[12:15], s64 offen offset:128 nt
    buffer_load_dwordx4 v[56:59], v4, s[12:15], s64 offen offset:2048 nt
    buffer_load_dwordx4 v[60:63], v4, s[12:15], s64 offen offset:2176 nt
    s_mov_b32 s100, 1
    s_waitcnt vmcnt(8)
    v_mov_b32 v8, 156464
    v_mov_b32 v9, 1
    s_mov_b64 s[74:75], exec
    s_mov_b64 exec, 1
    ds_add_u32 v8, v9
    s_mov_b64 exec, s[74:75]
    s_branch NOQ_2
Q7_4:
    s_waitcnt vmcnt(0)
    v_mov_b32 v8, 156464
    v_mov_b32 v9, 1
    s_mov_b64 s[74:75], exec
    s_mov_b64 exec, 1
    ds_add_u32 v8, v9
    s_mov_b64 exec, s[74:75]
    s_branch NOQ_2
Q8_3:
    s_load_dword s4, s[62:63], 0
    s_waitcnt lgkmcnt(0)
    s_add_u32 s4, s4, 0x9E3779B9
    s_mov_b32 s66, 0
    v_lshrrev_b32 v4, 2, v3
    v_lshl_add_u32 v4, v2, 2, v4
    v_bfe_u32 v5, v4, 1, 2
    s_and_b32 s65, s3, 3
    v_xor_b32 v5, s65, v5
    v_lshlrev_b32 v4, 7, v4
    v_lshl_add_u32 v4, v5, 5, v4
    v_and_b32 v5, 3, v1
    v_lshl_add_u32 v4, v5, 3, v4
    v_add_u32 v7, s66, v4
    v_and_b32 v5, 3, v1
    v_mul_u32_u24 v6, 1088, v5
    v_lshl_add_u32 v6, v2, 4, v6
    v_add_u32 v6, 147456, v6
    v_mov_b32 v8, 156464
    s_mov_b32 s82, 0
W_7:
    ds_read_b32 v9, v8
    s_waitcnt lgkmcnt(0)
    v_readfirstlane_b32 s71, v9
    s_cmp_ge_u32 s71, 8
    s_cbranch_scc1 WD_8
    s_sleep 1
    s_add_u32 s82, s82, 1
    s_cmp_lt_u32 s82, 4000000
    s_cbranch_scc1 W_7
    s_branch L_END
WD_8:
    ds_read_b64_tr_b16 v[32:33], v7 offset:0
    ds_read_b64_tr_b16 v[34:35], v7 offset:2048
    ds_read_b64_tr_b16 v[36:37], v7 offset:4096
    ds_read_b64_tr_b16 v[38:39], v7 offset:6144
    ds_read_b64_tr_b16 v[40:41], v7 offset:8192
    ds_read_b64_tr_b16 v[42:43], v7 offset:10240
    ds_read_b64_tr_b16 v[44:45], v7 offset:12288
    ds_read_b64_tr_b16 v[46:47], v7 offset:14336
    ds_read_b64_tr_b16 v[48:49], v7 offset:16384
    ds_read_b64_tr_b16 v[50:51], v7 offset:18432
    ds_read_b64_tr_b16 v[52:53], v7 offset:20480
    ds_read_b64_tr_b16 v[54:55], v7 offset:22528
    ds_read_b64_tr_b16 v[56:57], v7 offset:24576
    ds_read_b64_tr_b16 v[58:59], v7 offset:26624
    ds_read_b64_tr_b16 v[60:61], v7 offset:28672
    ds_read_b64_tr_b16 v[62:63], v7 offset:30720
    ds_read_b64_tr_b16 v[64:65], v7 offset:32768
    ds_read_b64_tr_b16 v[66:67], v7 offset:34816
    ds_read_b64_tr_b16 v[68:69], v7 offset:36864
    ds_read_b64_tr_b16 v[70:71], v7 offset:38912
    ds_read_b64_tr_b16 v[72:73], v7 offset:40960
    ds_read_b64_tr_b16 v[74:75], v7 offset:43008
    ds_read_b64_tr_b16 v[76:77], v7 offset:45056
    ds_read_b64_tr_b16 v[78:79], v7 offset:47104
    ds_read_b64_tr_b16 v[80:81], v7 offset:49152
    ds_read_b64_tr_b16 v[82:83], v7 offset:51200
    ds_read_b64_tr_b16 v[84:85], v7 offset:53248
    ds_read_b64_tr_b16 v[86:87], v7 offset:55296
    ds_read_b64_tr_b16 v[88:89], v7 offset:57344
    ds_read_b64_tr_b16 v[90:91], v7 offset:59392
    ds_read_b64_tr_b16 v[92:93], v7 offset:61440
    ds_read_b64_tr_b16 v[94:95], v7 offset:63488
    v_mov_b32 v8, 156420
    s_mov_b32 s82, 0
W_9:
    ds_read_b32 v9, v8
    s_waitcnt lgkmcnt(0)
    v_readfirstlane_b32 s71, v9
    s_cmp_ge_u32 s71, 4
    s_cbranch_scc1 WD_10
    s_sleep 1
    s_add_u32 s82, s82, 1
    s_cmp_lt_u32 s82, 4000000
    s_cbranch_scc1 W_9
    s_branch L_END
WD_10:
    ds_read_b128 v[8:11], v6 offset:0
    ds_read_b128 v[12:15], v6 offset:64
    ds_read_b128 v[16:19], v6 offset:128
    ds_read_b128 v[20:23], v6 offset:192
    ds_read_b128 v[112:115], v6 offset:256
    ds_read_b128 v[116:119], v6 offset:320
    ds_read_b128 v[120:123], v6 offset:384
    ds_read_b128 v[28:31], v6 offset:448
    s_waitcnt lgkmcnt(4)
    v_mfma_f32_16x16x32_bf16 v[24:27], v[32:35], v[8:11], 0
    v_mfma_f32_16x16x32_bf16 v[24:27], v[36:39], v[12:15], v[24:27]
    v_mfma_f32_16x16x32_bf16 v[24:27], v[40:43], v[16:19], v[24:27]
    v_mfma_f32_16x16x32_bf16 v[24:27], v[44:47], v[20:23], v[24:27]
    ds_read_b128 v[8:11], v6 offset:512
    ds_read_b128 v[12:15], v6 offset:576
    ds_read_b128 v[16:19], v6 offset:640
    ds_read_b128 v[20:23], v6 offset:704
    s_waitcnt lgkmcnt(4)
    v_mfma_f32_16x16x32_bf16 v[24:27], v[48:51], v[112:115], v[24:27]
    v_mfma_f32_16x16x32_bf16 v[24:27], v[52:55], v[116:119], v[24:27]
    v_mfma_f32_16x16x32_bf16 v[24:27], v[56:59], v[120:123], v[24:27]
    v_mfma_f32_16x16x32_bf16 v[24:27], v[60:63], v[28:31], v[24:27]
    ds_read_b128 v[112:115], v6 offset:768
    ds_read_b128 v[116:119], v6 offset:832
    ds_read_b128 v[120:123], v6 offset:896
    ds_read_b128 v[28:31], v6 offset:960
    s_waitcnt lgkmcnt(4)
    v_mfma_f32_16x16x32_bf16 v[24:27], v[64:67], v[8:11], v[24:27]
    v_mfma_f32_16x16x32_bf16 v[24:27], v[68:71], v[12:15], v[24:27]
    v_mfma_f32_16x16x32_bf16 v[24:27], v[72:75], v[16:19], v[24:27]
    v_mfma_f32_16x16x32_bf16 v[24:27], v[76:79], v[20:23], v[24:27]
    s_waitcnt lgkmcnt(0)
    v_mfma_f32_16x16x32_bf16 v[24:27], v[80:83], v[112:115], v[24:27]
    v_mfma_f32_16x16x32_bf16 v[24:27], v[84:87], v[116:119], v[24:27]
    v_mfma_f32_16x16x32_bf16 v[24:27], v[88:91], v[120:123], v[24:27]
    v_mfma_f32_16x16x32_bf16 v[24:27], v[92:95], v[28:31], v[24:27]
    s_nop 7
    v_cvt_pk_bf16_f32 v28, v24, v25
    v_mov_b32 v29, s4
    v_cvt_pk_bf16_f32 v30, v26, v27
    v_mov_b32 v31, s4
    s_and_b32 s66, s3, 3
    s_lshl_b32 s66, s66, 6
    s_add_u32 s65, s85, s66
    v_lshlrev_b32 v8, 14, v3
    v_lshl_add_u32 v8, v2, 4, v8
    v_cmp_gt_u32 vcc, 4, v3
    s_and_saveexec_b64 s[72:73], vcc
    buffer_store_dwordx4 v[28:31], v8, s[8:11], s65 offen sc1
    s_mov_b64 exec, s[72:73]
    v_mov_b32 v8, 156468
    v_mov_b32 v9, 1
    s_mov_b64 s[74:75], exec
    s_mov_b64 exec, 1
    ds_add_u32 v8, v9
    s_mov_b64 exec, s[74:75]
NOQ_2:
    v_and_b32 v8, 3, v1
    v_lshl_add_u32 v13, v2, 2, v8
    v_lshlrev_b32 v13, 4, v13
    v_add_u32 v13, 153856, v13
    s_cmp_ge_u32 s3, s78
    s_cbranch_scc1 L_S_ATT_IDLE
    s_cmp_eq_u32 s100, 1
    s_cbranch_scc1 KD_12
    s_cmp_lt_u32 s3, 10
    s_cbranch_scc1 K_11
    s_sub_u32 s69, s3, 9
    v_mov_b32 v8, 156432
    s_mov_b32 s82, 0
W_13:
    ds_read_b32 v9, v8
    s_waitcnt lgkmcnt(0)
    v_readfirstlane_b32 s71, v9
    s_cmp_ge_u32 s71, s69
    s_cbranch_scc1 WD_14
    s_sleep 1
    s_add_u32 s82, s82, 1
    s_cmp_lt_u32 s82, 4000000
    s_cbranch_scc1 W_13
    s_branch L_END
WD_14:
K_11:
    v_lshrrev_b32 v4, 2, v3
    v_and_b32 v5, 1, v1
    v_lshl_add_u32 v4, v4, 1, v5
    v_lshlrev_b32 v4, 8, v4
    v_bfe_u32 v5, v1, 1, 1
    v_lshl_add_u32 v4, v5, 6, v4
    v_lshl_add_u32 v4, v2, 4, v4
    s_add_u32 s64, s77, 4096
    buffer_load_dwordx4 v[32:35], v4, s[12:15], s77 offen offset:0 nt
    buffer_load_dwordx4 v[36:39], v4, s[12:15], s77 offen offset:128 nt
    buffer_load_dwordx4 v[40:43], v4, s[12:15], s77 offen offset:2048 nt
    buffer_load_dwordx4 v[44:47], v4, s[12:15], s77 offen offset:2176 nt
    buffer_load_dwordx4 v[48:51], v4, s[12:15], s64 offen offset:0 nt
    buffer_load_dwordx4 v[52:55], v4, s[12:15], s64 offen offset:128 nt
    buffer_load_dwordx4 v[56:59], v4, s[12:15], s64 offen offset:2048 nt
    buffer_load_dwordx4 v[60:63], v4, s[12:15], s64 offen offset:2176 nt
KD_12:
    s_load_dword s4, s[62:63], 0
    v_and_b32 v8, 3, v1
    v_mul_u32_u24 v10, 320, v8
    v_lshl_add_u32 v10, v2, 4, v10
    v_bfe_u32 v11, v1, 2, 1
    v_lshl_add_u32 v10, v11, 6, v10
    v_add_u32 v10, 151808, v10
    v_lshlrev_b32 v11, 6, v8
    v_add_u32 v11, 153600, v11
    s_lshl_b32 s64, s3, 2
    v_add_u32 v12, s64, v11
    s_lshl_b32 s64, s3, 8
    v_add_u32 v14, s64, v13
    s_waitcnt vmcnt(0)
    v_mov_b32 v8, 156432
    v_mov_b32 v9, 1
    s_mov_b64 s[74:75], exec
    s_mov_b64 exec, 1
    ds_add_u32 v8, v9
    s_mov_b64 exec, s[74:75]
    s_waitcnt lgkmcnt(0)
    s_add_u32 s4, s4, 0x9E3779B9
    v_mov_b32 v8, 156436
    s_mov_b32 s82, 0
W_15:
    ds_read_b32 v9, v8
    s_waitcnt lgkmcnt(0)
    v_readfirstlane_b32 s71, v9
    s_cmp_ge_u32 s71, 2
    s_cbranch_scc1 WD_16
    s_sleep 1
    s_add_u32 s82, s82, 1
    s_cmp_lt_u32 s82, 4000000
    s_cbranch_scc1 W_15
    s_branch L_END
WD_16:
    ds_read_b128 v[64:67], v10 offset:0
    ds_read_b128 v[68:71], v10 offset:128
    s_waitcnt lgkmcnt(0)
    v_mfma_f32_16x16x32_bf16 v[96:99], v[32:35], v[64:67], 0
    v_mfma_f32_16x16x32_bf16 v[100:103], v[40:43], v[64:67], 0
    v_mfma_f32_16x16x32_bf16 v[104:107], v[48:51], v[64:67], 0
    v_mfma_f32_16x16x32_bf16 v[108:111], v[56:59], v[64:67], 0
    v_mfma_f32_16x16x32_bf16 v[96:99], v[36:39], v[68:71], v[96:99]
    v_mfma_f32_16x16x32_bf16 v[100:103], v[44:47], v[68:71], v[100:103]
    v_mfma_f32_16x16x32_bf16 v[104:107], v[52:55], v[68:71], v[104:107]
    v_mfma_f32_16x16x32_bf16 v[108:111], v[60:63], v[68:71], v[108:111]
    s_mov_b32 s66, 0x3db504f3
    s_mov_b32 s67, 0x3db504f3
    s_mov_b32 s68, 0x3fb8aa3b
    s_nop 4
    v_add_f32_dpp v80, v98, v96 row_shl:4 row_mask:0xf bank_mask:0xf
    v_add_f32_dpp v81, v99, v97 row_shl:4 row_mask:0xf bank_mask:0xf
    v_add_f32_dpp v82, v102, v100 row_shl:4 row_mask:0xf bank_mask:0xf
    v_add_f32_dpp v83, v103, v101 row_shl:4 row_mask:0xf bank_mask:0xf
    v_add_f32_dpp v84, v106, v104 row_shl:4 row_mask:0xf bank_mask:0xf
    v_add_f32_dpp v85, v107, v105 row_shl:4 row_mask:0xf bank_mask:0xf
    v_add_f32_dpp v86, v110, v108 row_shl:4 row_mask:0xf bank_mask:0xf
    v_add_f32_dpp v87, v111, v109 row_shl:4 row_mask:0xf bank_mask:0xf
    v_cvt_pk_bf16_f32 v16, v80, v81
    v_lshlrev_b32 v80, 16, v16
    v_and_b32 v81, 0xffff0000, v16
    v_cvt_pk_bf16_f32 v16, v82, v83
    v_lshlrev_b32 v82, 16, v16
    v_and_b32 v83, 0xffff0000, v16
    v_cvt_pk_bf16_f32 v16, v84, v85
    v_lshlrev_b32 v84, 16, v16
    v_and_b32 v85, 0xffff0000, v16
    v_cvt_pk_bf16_f32 v16, v86, v87
    v_lshlrev_b32 v86, 16, v16
    v_and_b32 v87, 0xffff0000, v16
    v_pk_mul_f32 v[80:81], v[80:81], s[66:67]
    v_pk_mul_f32 v[82:83], v[82:83], s[66:67]
    v_pk_mul_f32 v[84:85], v[84:85], s[66:67]
    v_pk_mul_f32 v[86:87], v[86:87], s[66:67]
    v_cvt_pk_bf16_f32 v16, v80, v81
    v_lshlrev_b32 v80, 16, v16
    v_and_b32 v81, 0xffff0000, v16
    v_cvt_pk_bf16_f32 v16, v82, v83
    v_lshlrev_b32 v82, 16, v16
    v_and_b32 v83, 0xffff0000, v16
    v_cvt_pk_bf16_f32 v16, v84, v85
    v_lshlrev_b32 v84, 16, v16
    v_and_b32 v85, 0xffff0000, v16
    v_cvt_pk_bf16_f32 v16, v86, v87
    v_lshlrev_b32 v86, 16, v16
    v_and_b32 v87, 0xffff0000, v16
    v_max3_f32 v16, v80, v81, v82
    v_max3_f32 v16, v16, v83, v84
    v_max3_f32 v16, v16, v85, v86
    v_max_f32 v16, v16, v87
    v_mov_b32 v17, v16
    s_nop 1
    v_permlane16_swap_b32 v16, v17
    s_nop 0
    v_max_f32 v16, v16, v17
    v_mov_b32 v17, v16
    s_nop 1
    v_permlane32_swap_b32 v16, v17
    s_nop 0
    v_max_f32 v16, v16, v17
    v_cmp_gt_u32 vcc, 4, v1
    s_and_saveexec_b64 s[72:73], vcc
    ds_write_b32 v12, v16
    s_mov_b64 exec, s[72:73]
    v_mov_b32 v8, 156440
    v_mov_b32 v9, 1
    s_mov_b64 s[74:75], exec
    s_mov_b64 exec, 1
    ds_add_u32 v8, v9
    s_mov_b64 exec, s[74:75]
    v_mov_b32 v8, 156440
    s_mov_b32 s82, 0
W_17:
    ds_read_b32 v9, v8
    s_waitcnt lgkmcnt(0)
    v_readfirstlane_b32 s71, v9
    s_cmp_ge_u32 s71, s78
    s_cbranch_scc1 WD_18
    s_add_u32 s82, s82, 1
    s_cmp_lt_u32 s82, 4000000
    s_cbranch_scc1 W_17
    s_branch L_END
WD_18:
    ds_read_b128 v[16:19], v11 offset:0
    ds_read_b128 v[20:23], v11 offset:16
    ds_read_b128 v[24:27], v11 offset:32
    s_waitcnt lgkmcnt(0)
    v_max3_f32 v16, v16, v17, v18
    v_max3_f32 v19, v19, v20, v21
    v_max3_f32 v22, v22, v23, v24
    v_max3_f32 v25, v25, v26, v27
    v_max3_f32 v16, v16, v19, v22
    v_max_f32 v16, v16, v25
    v_mul_f32 v15, s68, v16
    v_fma_f32 v80, v80, s68, -v15
    v_fma_f32 v81, v81, s68, -v15
    v_fma_f32 v82, v82, s68, -v15
    v_fma_f32 v83, v83, s68, -v15
    v_fma_f32 v84, v84, s68, -v15
    v_fma_f32 v85, v85, s68, -v15
    v_fma_f32 v86, v86, s68, -v15
    v_fma_f32 v87, v87, s68, -v15
    v_exp_f32 v80, v80
    v_exp_f32 v81, v81
    v_exp_f32 v82, v82
    v_exp_f32 v83, v83
    v_exp_f32 v84, v84
    v_exp_f32 v85, v85
    v_exp_f32 v86, v86
    v_exp_f32 v87, v87
    s_nop 0
    v_cvt_pk_bf16_f32 v16, v80, v81
    v_cvt_pk_bf16_f32 v17, v82, v83
    v_cvt_pk_bf16_f32 v18, v84, v85
    v_cvt_pk_bf16_f32 v19, v86, v87
    v_cmp_gt_u32 vcc, 4, v3
    s_and_saveexec_b64 s[72:73], vcc
    ds_write_b128 v14, v[16:19]
    s_mov_b64 exec, s[72:73]
    v_mov_b32 v8, 156444
    v_mov_b32 v9, 1
    s_mov_b64 s[74:75], exec
    s_mov_b64 exec, 1
    ds_add_u32 v8, v9
    s_mov_b64 exec, s[74:75]
L_S_PVSTART:
    s_cmp_ge_u32 s3, 8
    s_cbranch_scc1 L_S_LATE
    v_bfe_u32 v9, v1, 3, 1
    v_bfe_u32 v10, v1, 2, 1
    v_lshl_add_u32 v10, v2, 1, v10
    v_lshl_add_u32 v11, v9, 3, v10
    v_lshlrev_b32 v9, 2, v9
    v_xor_b32 v10, v10, v9
    v_xor_b32 v10, s3, v10
    v_lshlrev_b32 v10, 5, v10
    v_lshl_add_u32 v10, v11, 8, v10
    v_and_b32 v11, 3, v1
    v_lshl_add_u32 v10, v11, 3, v10
    v_add_u32 v11, 0x10000, v10
    v_mov_b32 v28, 0x3f803f80
    v_mov_b32 v29, 0x3f803f80
    v_mov_b32 v30, 0x3f803f80
    v_mov_b32 v31, 0x3f803f80
    s_and_b32 s64, s6, 7
    s_lshr_b32 s65, s6, 3
    s_mul_i32 s65, s65, 7
    s_add_u32 s65, s65, s5
    s_mul_i32 s64, s64, 112
    s_add_u32 s64, s64, s65
    v_mul_u32_u24 v12, 28, v3
    v_add_u32 v12, s64, v12
    v_lshlrev_b32 v14, 4, v12
    v_lshlrev_b32 v12, 9, v12
    v_lshl_add_u32 v12, v2, 4, v12
    s_lshl_b32 s64, s3, 6
    v_add_u32 v12, s64, v12
    v_mov_b32 v17, s4
    v_mov_b32 v19, s4
    v_mov_b32 v21, s4
    v_mov_b32 v23, s4
    v_mov_b32 v8, 156444
    s_mov_b32 s82, 0
W_19:
    ds_read_b32 v9, v8
    s_waitcnt lgkmcnt(0)
    v_readfirstlane_b32 s71, v9
    s_cmp_ge_u32 s71, s78
    s_cbranch_scc1 WD_20
    s_add_u32 s82, s82, 1
    s_cmp_lt_u32 s82, 4000000
    s_cbranch_scc1 W_19
    s_branch L_END
WD_20:
    s_cmp_eq_u32 s78, 7
    s_cbranch_scc0 NT_21
    ds_read_b128 v[80:83], v13 offset:0
    ds_read_b128 v[84:87], v13 offset:256
    ds_read_b128 v[88:91], v13 offset:512
    ds_read_b128 v[92:95], v13 offset:768
    ds_read_b128 v[96:99], v13 offset:1024
    ds_read_b128 v[100:103], v13 offset:1280
    ds_read_b128 v[104:107], v13 offset:1536
    s_waitcnt lgkmcnt(6)
    v_mfma_f32_16x16x32_bf16 v[124:127], v[28:31], v[80:83], 0
    s_waitcnt lgkmcnt(5)
    v_mfma_f32_16x16x32_bf16 v[124:127], v[28:31], v[84:87], v[124:127]
    s_waitcnt lgkmcnt(4)
    v_mfma_f32_16x16x32_bf16 v[124:127], v[28:31], v[88:91], v[124:127]
    s_waitcnt lgkmcnt(3)
    v_mfma_f32_16x16x32_bf16 v[124:127], v[28:31], v[92:95], v[124:127]
    s_waitcnt lgkmcnt(2)
    v_mfma_f32_16x16x32_bf16 v[124:127], v[28:31], v[96:99], v[124:127]
    s_waitcnt lgkmcnt(1)
    v_mfma_f32_16x16x32_bf16 v[124:127], v[28:31], v[100:103], v[124:127]
    s_waitcnt lgkmcnt(0)
    v_mfma_f32_16x16x32_bf16 v[124:127], v[28:31], v[104:107], v[124:127]
    v_mov_b32 v8, 156448
    s_mov_b32 s82, 0
W_22:
    ds_read_b32 v9, v8
    s_waitcnt lgkmcnt(0)
    v_readfirstlane_b32 s71, v9
    s_and_b32 s71, s71, 63
    s_cmp_eq_u32 s71, 63
    s_cbranch_scc1 WD_23
    s_sleep 1
    s_add_u32 s82, s82, 1
    s_cmp_lt_u32 s82, 4000000
    s_cbranch_scc1 W_22
    s_branch L_END
WD_23:
    ds_read_b64_tr_b16 v[32:33], v10 offset:0
    ds_read_b64_tr_b16 v[34:35], v10 offset:4096
    ds_read_b64_tr_b16 v[36:37], v10 offset:8192
    ds_read_b64_tr_b16 v[38:39], v10 offset:12288
    ds_read_b64_tr_b16 v[40:41], v10 offset:16384
    ds_read_b64_tr_b16 v[42:43], v10 offset:20480
    ds_read_b64_tr_b16 v[44:45], v10 offset:24576
    ds_read_b64_tr_b16 v[46:47], v10 offset:28672
    ds_read_b64_tr_b16 v[48:49], v10 offset:32768
    ds_read_b64_tr_b16 v[50:51], v10 offset:36864
    ds_read_b64_tr_b16 v[52:53], v10 offset:40960
    ds_read_b64_tr_b16 v[54:55], v10 offset:45056
    s_waitcnt lgkmcnt(10)
    v_mfma_f32_16x16x32_bf16 v[120:123], v[32:35], v[80:83], 0
    s_waitcnt lgkmcnt(8)
    v_mfma_f32_16x16x32_bf16 v[120:123], v[36:39], v[84:87], v[120:123]
    s_waitcnt lgkmcnt(6)
    v_mfma_f32_16x16x32_bf16 v[120:123], v[40:43], v[88:91], v[120:123]
    s_waitcnt lgkmcnt(4)
    v_mfma_f32_16x16x32_bf16 v[120:123], v[44:47], v[92:95], v[120:123]
    s_waitcnt lgkmcnt(2)
    v_mfma_f32_16x16x32_bf16 v[120:123], v[48:51], v[96:99], v[120:123]
    s_waitcnt lgkmcnt(0)
    v_mfma_f32_16x16x32_bf16 v[120:123], v[52:55], v[100:103], v[120:123]
    v_rcp_f32 v24, v124
    v_mov_b32 v8, 156448
    s_mov_b32 s82, 0
W_24:
    ds_read_b32 v9, v8
    s_waitcnt lgkmcnt(0)
    v_readfirstlane_b32 s71, v9
    s_and_b32 s71, s71, 127
    s_cmp_eq_u32 s71, 127
    s_cbranch_scc1 WD_25
    s_add_u32 s82, s82, 1
    s_cmp_lt_u32 s82, 4000000
    s_cbranch_scc1 W_24
    s_branch L_END
WD_25:
    ds_read_b64_tr_b16 v[56:57], v10 offset:49152
    ds_read_b64_tr_b16 v[58:59], v10 offset:53248
    s_waitcnt lgkmcnt(0)
    v_mfma_f32_16x16x32_bf16 v[120:123], v[56:59], v[104:107], v[120:123]
    s_branch L_S_PVEND
NT_21:
    ds_read_b128 v[80:83], v13 offset:0
    ds_read_b128 v[84:87], v13 offset:256
    ds_read_b128 v[88:91], v13 offset:512
    ds_read_b128 v[92:95], v13 offset:768
    ds_read_b128 v[96:99], v13 offset:1024
    ds_read_b128 v[100:103], v13 offset:1280
    ds_read_b128 v[104:107], v13 offset:1536
    ds_read_b128 v[108:111], v13 offset:1792
    ds_read_b128 v[112:115], v13 offset:2048
    ds_read_b128 v[116:119], v13 offset:2304
    s_waitcnt lgkmcnt(9)
    v_mfma_f32_16x16x32_bf16 v[124:127], v[28:31], v[80:83], 0
    s_waitcnt lgkmcnt(8)
    v_mfma_f32_16x16x32_bf16 v[124:127], v[28:31], v[84:87], v[124:127]
    s_waitcnt lgkmcnt(7)
    v_mfma_f32_16x16x32_bf16 v[124:127], v[28:31], v[88:91], v[124:127]
    s_waitcnt lgkmcnt(6)
    v_mfma_f32_16x16x32_bf16 v[124:127], v[28:31], v[92:95], v[124:127]
    s_waitcnt lgkmcnt(5)
    v_mfma_f32_16x16x32_bf16 v[124:127], v[28:31], v[96:99], v[124:127]
    s_waitcnt lgkmcnt(4)
    v_mfma_f32_16x16x32_bf16 v[124:127], v[28:31], v[100:103], v[124:127]
    s_waitcnt lgkmcnt(3)
    v_mfma_f32_16x16x32_bf16 v[124:127], v[28:31], v[104:107], v[124:127]
    s_waitcnt lgkmcnt(2)
    v_mfma_f32_16x16x32_bf16 v[124:127], v[28:31], v[108:111], v[124:127]
    s_waitcnt lgkmcnt(1)
    v_mfma_f32_16x16x32_bf16 v[124:127], v[28:31], v[112:115], v[124:127]
    s_waitcnt lgkmcnt(0)
    v_mfma_f32_16x16x32_bf16 v[124:127], v[28:31], v[116:119], v[124:127]
    v_mov_b32 v8, 156448
    s_mov_b32 s82, 0
W_27:
    ds_read_b32 v9, v8
    s_waitcnt lgkmcnt(0)
    v_readfirstlane_b32 s71, v9
    s_and_b32 s71, s71, 511
    s_cmp_eq_u32 s71, 511
    s_cbranch_scc1 WD_28
    s_sleep 1
    s_add_u32 s82, s82, 1
    s_cmp_lt_u32 s82, 4000000
    s_cbranch_scc1 W_27
    s_branch L_END
WD_28:
    ds_read_b64_tr_b16 v[32:33], v10 offset:0
    ds_read_b64_tr_b16 v[34:35], v10 offset:4096
    ds_read_b64_tr_b16 v[36:37], v10 offset:8192
    ds_read_b64_tr_b16 v[38:39], v10 offset:12288
    ds_read_b64_tr_b16 v[40:41], v10 offset:16384
    ds_read_b64_tr_b16 v[42:43], v10 offset:20480
    ds_read_b64_tr_b16 v[44:45], v10 offset:24576
    ds_read_b64_tr_b16 v[46:47], v10 offset:28672
    ds_read_b64_tr_b16 v[48:49], v10 offset:32768
    ds_read_b64_tr_b16 v[50:51], v10 offset:36864
    ds_read_b64_tr_b16 v[52:53], v10 offset:40960
    ds_read_b64_tr_b16 v[54:55], v10 offset:45056
    ds_read_b64_tr_b16 v[56:57], v10 offset:49152
    ds_read_b64_tr_b16 v[58:59], v10 offset:53248
    s_waitcnt lgkmcnt(12)
    v_mfma_f32_16x16x32_bf16 v[120:123], v[32:35], v[80:83], 0
    ds_read_b64_tr_b16 v[60:61], v10 offset:57344
    ds_read_b64_tr_b16 v[62:63], v10 offset:61440
    s_waitcnt lgkmcnt(12)
    v_mfma_f32_16x16x32_bf16 v[120:123], v[36:39], v[84:87], v[120:123]
    ds_read_b64_tr_b16 v[64:65], v11 offset:0
    ds_read_b64_tr_b16 v[66:67], v11 offset:4096
    s_waitcnt lgkmcnt(12)
    v_mfma_f32_16x16x32_bf16 v[120:123], v[40:43], v[88:91], v[120:123]
    s_waitcnt lgkmcnt(10)
    v_mfma_f32_16x16x32_bf16 v[120:123], v[44:47], v[92:95], v[120:123]
    s_waitcnt lgkmcnt(8)
    v_mfma_f32_16x16x32_bf16 v[120:123], v[48:51], v[96:99], v[120:123]
    s_waitcnt lgkmcnt(6)
    v_mfma_f32_16x16x32_bf16 v[120:123], v[52:55], v[100:103], v[120:123]
    s_waitcnt lgkmcnt(4)
    v_mfma_f32_16x16x32_bf16 v[120:123], v[56:59], v[104:107], v[120:123]
    s_waitcnt lgkmcnt(2)
    v_mfma_f32_16x16x32_bf16 v[120:123], v[60:63], v[108:111], v[120:123]
    s_waitcnt lgkmcnt(0)
    v_mfma_f32_16x16x32_bf16 v[120:123], v[64:67], v[112:115], v[120:123]
    v_rcp_f32 v24, v124
    v_mov_b32 v8, 156448
    s_mov_b32 s82, 0
W_29:
    ds_read_b32 v9, v8
    s_waitcnt lgkmcnt(0)
    v_readfirstlane_b32 s71, v9
    s_and_b32 s71, s71, 1023
    s_cmp_eq_u32 s71, 1023
    s_cbranch_scc1 WD_30
    s_add_u32 s82, s82, 1
    s_cmp_lt_u32 s82, 4000000
    s_cbranch_scc1 W_29
    s_branch L_END
WD_30:
    ds_read_b64_tr_b16 v[68:69], v11 offset:8192
    ds_read_b64_tr_b16 v[70:71], v11 offset:12288
    s_waitcnt lgkmcnt(0)
    v_mfma_f32_16x16x32_bf16 v[120:123], v[68:71], v[116:119], v[120:123]
L_S_PVEND:
    v_mov_b32 v8, 156452
    v_mov_b32 v9, 1
    s_mov_b64 s[74:75], exec
    s_mov_b64 exec, 1
    ds_add_u32 v8, v9
    s_mov_b64 exec, s[74:75]
    v_mov_b32 v20, v15
    v_mov_b32 v22, v124
    s_nop 1
    v_pk_mul_f32 v[120:121], v[120:121], v[24:25] op_sel_hi:[1,0]
    v_pk_mul_f32 v[122:123], v[122:123], v[24:25] op_sel_hi:[1,0]
    v_cvt_pk_bf16_f32 v16, v120, v121
    v_cvt_pk_bf16_f32 v18, v122, v123
    s_mov_b32 s66, 262144
    v_cmp_gt_u32 vcc, 4, v3
    s_and_saveexec_b64 s[72:73], vcc
    buffer_store_dwordx4 v[16:19], v12, s[8:11], s66 offen sc1
    s_cmp_lg_u32 s3, 0
    s_cbranch_scc1 ML_31
    s_mov_b64 exec, 15
    s_mov_b32 s66, 131072
    buffer_store_dwordx4 v[20:23], v14, s[8:11], s66 offen sc1
ML_31:
    s_mov_b64 exec, s[72:73]
    s_branch L_S_LATE
L_S_ATT_IDLE:
    s_load_dword s4, s[62:63], 0
    s_waitcnt lgkmcnt(0)
    s_add_u32 s4, s4, 0x9E3779B9
    s_branch L_S_PVSTART
L_S_JOB:
    s_setprio 3
    v_lshlrev_b32 v4, 2, v1
    v_add_u32 v5, 153600, v4
    v_mov_b32 v6, 0xff800000
    ds_write_b32 v5, v6
    v_add_u32 v4, 156416, v4
    v_mov_b32 v5, 0
    v_cmp_gt_u32 vcc, 16, v1
    s_and_saveexec_b64 s[72:73], vcc
    ds_write_b32 v4, v5
    s_mov_b64 exec, s[72:73]
    s_waitcnt lgkmcnt(0)
    s_barrier
    s_load_dword s4, s[62:63], 0
    s_sub_u32 s68, s3, 10
    s_waitcnt lgkmcnt(0)
    s_add_u32 s4, s4, 0x9E3779B9
    s_cmp_eq_u32 s79, 0
    s_cbranch_scc1 L_S_JOB_Q
    v_lshrrev_b32 v4, 2, v3
    v_lshl_add_u32 v4, v2, 2, v4
    v_lshlrev_b32 v4, 6, v4
    v_and_b32 v5, 1, v2
    v_xor_b32 v5, s68, v5
    v_lshl_add_u32 v4, v5, 5, v4
    v_and_b32 v5, 3, v1
    v_lshl_add_u32 v4, v5, 3, v4
    v_add_u32 v4, 81920, v4
    v_mul_u32_u24 v6, 1088, v5
    v_lshl_add_u32 v6, v2, 4, v6
    v_add_u32 v6, 147456, v6
    v_mov_b32 v8, 156416
    s_mov_b32 s82, 0
W_32:
    ds_read_b32 v9, v8
    s_waitcnt lgkmcnt(0)
    v_readfirstlane_b32 s71, v9
    s_cmp_ge_u32 s71, 4
    s_cbranch_scc1 WD_33
    s_sleep 1
    s_add_u32 s82, s82, 1
    s_cmp_lt_u32 s82, 4000000
    s_cbranch_scc1 W_32
    s_branch L_END
WD_33:
    ds_read_b64_tr_b16 v[32:33], v4 offset:0
    ds_read_b64_tr_b16 v[34:35], v4 offset:1024
    ds_read_b64_tr_b16 v[36:37], v4 offset:2048
    ds_read_b64_tr_b16 v[38:39], v4 offset:3072
    ds_read_b64_tr_b16 v[40:41], v4 offset:4096
    ds_read_b64_tr_b16 v[42:43], v4 offset:5120
    ds_read_b64_tr_b16 v[44:45], v4 offset:6144
    ds_read_b64_tr_b16 v[46:47], v4 offset:7168
    ds_read_b64_tr_b16 v[48:49], v4 offset:8192
    ds_read_b64_tr_b16 v[50:51], v4 offset:9216
    ds_read_b64_tr_b16 v[52:53], v4 offset:10240
    ds_read_b64_tr_b16 v[54:55], v4 offset:11264
    ds_read_b64_tr_b16 v[56:57], v4 offset:12288
    ds_read_b64_tr_b16 v[58:59], v4 offset:13312
    ds_read_b64_tr_b16 v[60:61], v4 offset:14336
    ds_read_b64_tr_b16 v[62:63], v4 offset:15360
    ds_read_b64_tr_b16 v[64:65], v4 offset:16384
    ds_read_b64_tr_b16 v[66:67], v4 offset:17408
    ds_read_b64_tr_b16 v[68:69], v4 offset:18432
    ds_read_b64_tr_b16 v[70:71], v4 offset:19456
    ds_read_b64_tr_b16 v[72:73], v4 offset:20480
    ds_read_b64_tr_b16 v[74:75], v4 offset:21504
    ds_read_b64_tr_b16 v[76:77], v4 offset:22528
    ds_read_b64_tr_b16 v[78:79], v4 offset:23552
    ds_read_b64_tr_b16 v[80:81], v4 offset:24576
    ds_read_b64_tr_b16 v[82:83], v4 offset:25600
    ds_read_b64_tr_b16 v[84:85], v4 offset:26624
    ds_read_b64_tr_b16 v[86:87], v4 offset:27648
    ds_read_b64_tr_b16 v[88:89], v4 offset:28672
    ds_read_b64_tr_b16 v[90:91], v4 offset:29696
    ds_read_b64_tr_b16 v[92:93], v4 offset:30720
    ds_read_b64_tr_b16 v[94:95], v4 offset:31744
    v_mov_b32 v8, 156420
    s_mov_b32 s82, 0
W_34:
    ds_read_b32 v9, v8
    s_waitcnt lgkmcnt(0)
    v_readfirstlane_b32 s71, v9
    s_cmp_ge_u32 s71, 4
    s_cbranch_scc1 WD_35
    s_sleep 1
    s_add_u32 s82, s82, 1
    s_cmp_lt_u32 s82, 4000000
    s_cbranch_scc1 W_34
    s_branch L_END
WD_35:
    ds_read_b128 v[96:99], v6 offset:0
    ds_read_b128 v[100:103], v6 offset:64
    ds_read_b128 v[104:107], v6 offset:128
    ds_read_b128 v[108:111], v6 offset:192
    ds_read_b128 v[8:11], v6 offset:256
    ds_read_b128 v[12:15], v6 offset:320
    ds_read_b128 v[16:19], v6 offset:384
    ds_read_b128 v[20:23], v6 offset:448
    s_waitcnt lgkmcnt(4)
    v_mfma_f32_16x16x32_bf16 v[24:27], v[32:35], v[96:99], 0
    v_mfma_f32_16x16x32_bf16 v[24:27], v[36:39], v[100:103], v[24:27]
    v_mfma_f32_16x16x32_bf16 v[24:27], v[40:43], v[104:107], v[24:27]
    v_mfma_f32_16x16x32_bf16 v[24:27], v[44:47], v[108:111], v[24:27]
    ds_read_b128 v[96:99], v6 offset:512
    ds_read_b128 v[100:103], v6 offset:576
    ds_read_b128 v[104:107], v6 offset:640
    ds_read_b128 v[108:111], v6 offset:704
    s_waitcnt lgkmcnt(4)
    v_mfma_f32_16x16x32_bf16 v[24:27], v[48:51], v[8:11], v[24:27]
    v_mfma_f32_16x16x32_bf16 v[24:27], v[52:55], v[12:15], v[24:27]
    v_mfma_f32_16x16x32_bf16 v[24:27], v[56:59], v[16:19], v[24:27]
    v_mfma_f32_16x16x32_bf16 v[24:27], v[60:63], v[20:23], v[24:27]
    ds_read_b128 v[8:11], v6 offset:768
    ds_read_b128 v[12:15], v6 offset:832
    ds_read_b128 v[16:19], v6 offset:896
    ds_read_b128 v[20:23], v6 offset:960
    s_waitcnt lgkmcnt(4)
    v_mfma_f32_16x16x32_bf16 v[24:27], v[64:67], v[96:99], v[24:27]
    v_mfma_f32_16x16x32_bf16 v[24:27], v[68:71], v[100:103], v[24:27]
    v_mfma_f32_16x16x32_bf16 v[24:27], v[72:75], v[104:107], v[24:27]
    v_mfma_f32_16x16x32_bf16 v[24:27], v[76:79], v[108:111], v[24:27]
    s_waitcnt lgkmcnt(0)
    v_mfma_f32_16x16x32_bf16 v[24:27], v[80:83], v[8:11], v[24:27]
    v_mfma_f32_16x16x32_bf16 v[24:27], v[84:87], v[12:15], v[24:27]
    v_mfma_f32_16x16x32_bf16 v[24:27], v[88:91], v[16:19], v[24:27]
    v_mfma_f32_16x16x32_bf16 v[24:27], v[92:95], v[20:23], v[24:27]
    s_nop 7
    v_cvt_pk_bf16_f32 v28, v24, v25
    v_mov_b32 v29, s4
    v_cvt_pk_bf16_f32 v30, v26, v27
    v_mov_b32 v31, s4
    s_lshl_b32 s65, s80, 7
    s_add_u32 s65, s65, 32768
    s_lshl_b32 s66, s68, 6
    s_add_u32 s65, s65, s66
    v_lshlrev_b32 v8, 13, v3
    v_lshl_add_u32 v8, v2, 4, v8
    v_cmp_gt_u32 vcc, 4, v3
    s_and_saveexec_b64 s[72:73], vcc
    buffer_store_dwordx4 v[28:31], v8, s[8:11], s65 offen sc1
    s_mov_b64 exec, s[72:73]
L_S_JOB_Q:
    s_cmp_eq_u32 s95, 0
    s_cbranch_scc1 JQ_36
    s_lshl_b32 s84, s80, 7
    s_lshl_b32 s85, s80, 8
    s_add_u32 s85, s85, 65536
    s_mov_b32 s66, 0
    v_lshrrev_b32 v4, 2, v3
    v_lshl_add_u32 v4, v2, 2, v4
    v_bfe_u32 v5, v4, 1, 2
    s_and_b32 s65, s3, 3
    v_xor_b32 v5, s65, v5
    v_lshlrev_b32 v4, 7, v4
    v_lshl_add_u32 v4, v5, 5, v4
    v_and_b32 v5, 3, v1
    v_lshl_add_u32 v4, v5, 3, v4
    v_add_u32 v7, s66, v4
    v_and_b32 v5, 3, v1
    v_mul_u32_u24 v6, 1088, v5
    v_lshl_add_u32 v6, v2, 4, v6
    v_add_u32 v6, 147456, v6
    v_mov_b32 v8, 156464
    s_mov_b32 s82, 0
W_37:
    ds_read_b32 v9, v8
    s_waitcnt lgkmcnt(0)
    v_readfirstlane_b32 s71, v9
    s_cmp_ge_u32 s71, 8
    s_cbranch_scc1 WD_38
    s_sleep 1
    s_add_u32 s82, s82, 1
    s_cmp_lt_u32 s82, 4000000
    s_cbranch_scc1 W_37
    s_branch L_END
WD_38:
    ds_read_b64_tr_b16 v[32:33], v7 offset:0
    ds_read_b64_tr_b16 v[34:35], v7 offset:2048
    ds_read_b64_tr_b16 v[36:37], v7 offset:4096
    ds_read_b64_tr_b16 v[38:39], v7 offset:6144
    ds_read_b64_tr_b16 v[40:41], v7 offset:8192
    ds_read_b64_tr_b16 v[42:43], v7 offset:10240
    ds_read_b64_tr_b16 v[44:45], v7 offset:12288
    ds_read_b64_tr_b16 v[46:47], v7 offset:14336
    ds_read_b64_tr_b16 v[48:49], v7 offset:16384
    ds_read_b64_tr_b16 v[50:51], v7 offset:18432
    ds_read_b64_tr_b16 v[52:53], v7 offset:20480
    ds_read_b64_tr_b16 v[54:55], v7 offset:22528
    ds_read_b64_tr_b16 v[56:57], v7 offset:24576
    ds_read_b64_tr_b16 v[58:59], v7 offset:26624
    ds_read_b64_tr_b16 v[60:61], v7 offset:28672
    ds_read_b64_tr_b16 v[62:63], v7 offset:30720
    ds_read_b64_tr_b16 v[64:65], v7 offset:32768
    ds_read_b64_tr_b16 v[66:67], v7 offset:34816
    ds_read_b64_tr_b16 v[68:69], v7 offset:36864
    ds_read_b64_tr_b16 v[70:71], v7 offset:38912
    ds_read_b64_tr_b16 v[72:73], v7 offset:40960
    ds_read_b64_tr_b16 v[74:75], v7 offset:43008
    ds_read_b64_tr_b16 v[76:77], v7 offset:45056
    ds_read_b64_tr_b16 v[78:79], v7 offset:47104
    ds_read_b64_tr_b16 v[80:81], v7 offset:49152
    ds_read_b64_tr_b16 v[82:83], v7 offset:51200
    ds_read_b64_tr_b16 v[84:85], v7 offset:53248
    ds_read_b64_tr_b16 v[86:87], v7 offset:55296
    ds_read_b64_tr_b16 v[88:89], v7 offset:57344
    ds_read_b64_tr_b16 v[90:91], v7 offset:59392
    ds_read_b64_tr_b16 v[92:93], v7 offset:61440
    ds_read_b64_tr_b16 v[94:95], v7 offset:63488
    v_mov_b32 v8, 156420
    s_mov_b32 s82, 0
W_39:
    ds_read_b32 v9, v8
    s_waitcnt lgkmcnt(0)
    v_readfirstlane_b32 s71, v9
    s_cmp_ge_u32 s71, 4
    s_cbranch_scc1 WD_40
    s_sleep 1
    s_add_u32 s82, s82, 1
    s_cmp_lt_u32 s82, 4000000
    s_cbranch_scc1 W_39
    s_branch L_END
WD_40:
    ds_read_b128 v[8:11], v6 offset:0
    ds_read_b128 v[12:15], v6 offset:64
    ds_read_b128 v[16:19], v6 offset:128
    ds_read_b128 v[20:23], v6 offset:192
    ds_read_b128 v[112:115], v6 offset:256
    ds_read_b128 v[116:119], v6 offset:320
    ds_read_b128 v[120:123], v6 offset:384
    ds_read_b128 v[28:31], v6 offset:448
    s_waitcnt lgkmcnt(4)
    v_mfma_f32_16x16x32_bf16 v[24:27], v[32:35], v[8:11], 0
    v_mfma_f32_16x16x32_bf16 v[24:27], v[36:39], v[12:15], v[24:27]
    v_mfma_f32_16x16x32_bf16 v[24:27], v[40:43], v[16:19], v[24:27]
    v_mfma_f32_16x16x32_bf16 v[24:27], v[44:47], v[20:23], v[24:27]
    ds_read_b128 v[8:11], v6 offset:512
    ds_read_b128 v[12:15], v6 offset:576
    ds_read_b128 v[16:19], v6 offset:640
    ds_read_b128 v[20:23], v6 offset:704
    s_waitcnt lgkmcnt(4)
    v_mfma_f32_16x16x32_bf16 v[24:27], v[48:51], v[112:115], v[24:27]
    v_mfma_f32_16x16x32_bf16 v[24:27], v[52:55], v[116:119], v[24:27]
    v_mfma_f32_16x16x32_bf16 v[24:27], v[56:59], v[120:123], v[24:27]
    v_mfma_f32_16x16x32_bf16 v[24:27], v[60:63], v[28:31], v[24:27]
    ds_read_b128 v[112:115], v6 offset:768
    ds_read_b128 v[116:119], v6 offset:832
    ds_read_b128 v[120:123], v6 offset:896
    ds_read_b128 v[28:31], v6 offset:960
    s_waitcnt lgkmcnt(4)
    v_mfma_f32_16x16x32_bf16 v[24:27], v[64:67], v[8:11], v[24:27]
    v_mfma_f32_16x16x32_bf16 v[24:27], v[68:71], v[12:15], v[24:27]
    v_mfma_f32_16x16x32_bf16 v[24:27], v[72:75], v[16:19], v[24:27]
    v_mfma_f32_16x16x32_bf16 v[24:27], v[76:79], v[20:23], v[24:27]
    s_waitcnt lgkmcnt(0)
    v_mfma_f32_16x16x32_bf16 v[24:27], v[80:83], v[112:115], v[24:27]
    v_mfma_f32_16x16x32_bf16 v[24:27], v[84:87], v[116:119], v[24:27]
    v_mfma_f32_16x16x32_bf16 v[24:27], v[88:91], v[120:123], v[24:27]
    v_mfma_f32_16x16x32_bf16 v[24:27], v[92:95], v[28:31], v[24:27]
    s_nop 7
    v_cvt_pk_bf16_f32 v28, v24, v25
    v_mov_b32 v29, s4
    v_cvt_pk_bf16_f32 v30, v26, v27
    v_mov_b32 v31, s4
    s_and_b32 s66, s3, 3
    s_lshl_b32 s66, s66, 6
    s_add_u32 s65, s85, s66
    v_lshlrev_b32 v8, 14, v3
    v_lshl_add_u32 v8, v2, 4, v8
    v_cmp_gt_u32 vcc, 4, v3
    s_and_saveexec_b64 s[72:73], vcc
    buffer_store_dwordx4 v[28:31], v8, s[8:11], s65 offen sc1
    s_mov_b64 exec, s[72:73]
    v_mov_b32 v8, 156468
    v_mov_b32 v9, 1
    s_mov_b64 s[74:75], exec
    s_mov_b64 exec, 1
    ds_add_u32 v8, v9
    s_mov_b64 exec, s[74:75]
    s_sub_u32 s68, s3, 10
    v_mov_b32 v8, 156468
    s_mov_b32 s82, 0
W_41:
    ds_read_b32 v9, v8
    s_waitcnt lgkmcnt(0)
    v_readfirstlane_b32 s71, v9
    s_cmp_ge_u32 s71, 4
    s_cbranch_scc1 WD_42
    s_sleep 2
    s_add_u32 s82, s82, 1
    s_cmp_lt_u32 s82, 4000000
    s_cbranch_scc1 W_41
    s_branch L_END
WD_42:
JQ_36:
    s_lshr_b32 s64, s6, 3
    s_lshl_b32 s64, s64, 14
    s_and_b32 s65, s6, 7
    s_lshl_b32 s65, s65, 11
    s_add_u32 s64, s64, s65
    s_lshl_b32 s65, s68, 10
    s_add_u32 s64, s64, s65
    s_add_u32 s64, s64, 65536
    v_lshlrev_b32 v5, 4, v1
    v_add_u32 v5, s64, v5
    v_lshrrev_b32 v6, 5, v1
    s_lshl_b32 s64, s68, 1
    v_add_u32 v6, s64, v6
    v_mul_u32_u24 v6, 320, v6
    v_and_b32 v7, 31, v1
    v_lshl_add_u32 v6, v7, 3, v6
    v_add_u32 v6, 151808, v6
    s_mov_b32 s82, 0
P_44:
    buffer_load_dwordx4 v[8:11], v5, s[8:11], 0 offen offset:0 sc1
    s_waitcnt vmcnt(0)
    v_cmp_eq_u32 vcc, s4, v9
    v_cmp_eq_u32 s[72:73], s4, v11
    s_and_b64 vcc, vcc, s[72:73]
    s_cmp_eq_u64 vcc, exec
    s_cbranch_scc1 PD_43
    s_sleep 2
    s_add_u32 s82, s82, 1
    s_cmp_lt_u32 s82, 200000
    s_cbranch_scc1 P_44
    s_branch L_END
PD_43:
    v_mov_b32 v9, v10
    ds_write_b64 v6, v[8:9]
    v_mov_b32 v24, 156436
    v_mov_b32 v25, 1
    s_mov_b64 s[74:75], exec
    s_mov_b64 exec, 1
    ds_add_u32 v24, v25
    s_mov_b64 exec, s[74:75]
    s_branch L_S_LATE
L_S_STREAM:
    s_setprio 2
    s_sub_u32 s68, s3, 12
    s_barrier
    s_cmp_eq_u32 s79, 0
    s_cbranch_scc1 NOE_45
    s_mov_b32 s28, s54
    s_and_b32 s29, s55, 0xffff
    s_mov_b32 s30, 4096
    s_mov_b32 s31, 0x20000
    s_mov_b32 s20, s56
    s_and_b32 s21, s57, 0xffff
    s_mov_b32 s22, 3145728
    s_mov_b32 s23, 0x20000
    s_lshl_b32 s64, s68, 10
    v_lshlrev_b32 v4, 4, v1
    buffer_load_dwordx4 v[8:11], v4, s[28:31], s64 offen
    s_lshl_b32 s84, s80, 6
    s_add_u32 s84, s84, 2048
    s_add_u32 s85, s84, 32
    v_lshrrev_b32 v5, 2, v1
    v_mul_u32_u24 v5, 6144, v5
    v_bfe_u32 v6, v1, 1, 1
    v_bfe_u32 v7, v1, 4, 1
    v_xor_b32 v6, v6, v7
    v_mov_b32 v7, s84
    v_mov_b32 v16, s85
    v_cmp_eq_u32 vcc, 1, v6
    s_nop 1
    v_cndmask_b32 v7, v7, v16, vcc
    v_add_u32 v5, v5, v7
    v_and_b32 v6, 1, v1
    v_lshl_add_u32 v5, v6, 4, v5
    s_lshl_b32 s65, s68, 3
    s_mul_i32 s66, s65, 98304
    s_lshl_b32 s65, s65, 10
    s_add_u32 s65, s65, 81920
    s_mov_b32 m0, s65
    s_add_u32 s65, s65, 1024
    buffer_load_dwordx4 v5, s[20:23], s66 offen nt lds
    s_add_u32 s66, s66, 98304
    s_mov_b32 m0, s65
    s_add_u32 s65, s65, 1024
    buffer_load_dwordx4 v5, s[20:23], s66 offen nt lds
    s_add_u32 s66, s66, 98304
    s_mov_b32 m0, s65
    s_add_u32 s65, s65, 1024
    buffer_load_dwordx4 v5, s[20:23], s66 offen nt lds
    s_add_u32 s66, s66, 98304
    s_mov_b32 m0, s65
    s_add_u32 s65, s65, 1024
    buffer_load_dwordx4 v5, s[20:23], s66 offen nt lds
    s_add_u32 s66, s66, 98304
    s_mov_b32 m0, s65
    s_add_u32 s65, s65, 1024
    buffer_load_dwordx4 v5, s[20:23], s66 offen nt lds
    s_add_u32 s66, s66, 98304
    s_mov_b32 m0, s65
    s_add_u32 s65, s65, 1024
    buffer_load_dwordx4 v5, s[20:23], s66 offen nt lds
    s_add_u32 s66, s66, 98304
    s_mov_b32 m0, s65
    s_add_u32 s65, s65, 1024
    buffer_load_dwordx4 v5, s[20:23], s66 offen nt lds
    s_add_u32 s66, s66, 98304
    s_mov_b32 m0, s65
    s_add_u32 s65, s65, 1024
    buffer_load_dwordx4 v5, s[20:23], s66 offen nt lds
    s_add_u32 s66, s66, 98304
NOE_45:
    s_load_dword s4, s[62:63], 0
    s_mov_b32 s16, s40
    s_and_b32 s17, s41, 0xffff
    s_mov_b32 s18, 67108864
    s_mov_b32 s19, 0x20000
    s_mov_b32 s24, s44
    s_and_b32 s25, s45, 0xffff
    s_mov_b32 s26, 4194304
    s_mov_b32 s27, 0x20000
    s_cmp_eq_u32 s79, 0
    s_cbranch_scc1 LAF_46
    s_waitcnt vmcnt(8)
    v_lshlrev_b32 v16, 16, v8
    v_and_b32 v17, 0xffff0000, v8
    v_lshlrev_b32 v18, 16, v9
    v_and_b32 v19, 0xffff0000, v9
    v_lshlrev_b32 v20, 16, v10
    v_and_b32 v21, 0xffff0000, v10
    v_lshlrev_b32 v22, 16, v11
    v_and_b32 v23, 0xffff0000, v11
    v_mul_f32 v24, 0xbfb8aa3b, v16
    v_exp_f32 v24, v24
    s_nop 0
    v_add_f32 v24, 1.0, v24
    v_rcp_f32 v25, v24
    s_nop 0
    v_mul_f32 v16, v16, v25
    v_mul_f32 v24, 0xbfb8aa3b, v17
    v_exp_f32 v24, v24
    s_nop 0
    v_add_f32 v24, 1.0, v24
    v_rcp_f32 v25, v24
    s_nop 0
    v_mul_f32 v17, v17, v25
    v_mul_f32 v24, 0xbfb8aa3b, v18
    v_exp_f32 v24, v24
    s_nop 0
    v_add_f32 v24, 1.0, v24
    v_rcp_f32 v25, v24
    s_nop 0
    v_mul_f32 v18, v18, v25
    v_mul_f32 v24, 0xbfb8aa3b, v19
    v_exp_f32 v24, v24
    s_nop 0
    v_add_f32 v24, 1.0, v24
    v_rcp_f32 v25, v24
    s_nop 0
    v_mul_f32 v19, v19, v25
    v_mul_f32 v24, 0xbfb8aa3b, v20
    v_exp_f32 v24, v24
    s_nop 0
    v_add_f32 v24, 1.0, v24
    v_rcp_f32 v25, v24
    s_nop 0
    v_mul_f32 v20, v20, v25
    v_mul_f32 v24, 0xbfb8aa3b, v21
    v_exp_f32 v24, v24
    s_nop 0
    v_add_f32 v24, 1.0, v24
    v_rcp_f32 v25, v24
    s_nop 0
    v_mul_f32 v21, v21, v25
    v_mul_f32 v24, 0xbfb8aa3b, v22
    v_exp_f32 v24, v24
    s_nop 0
    v_add_f32 v24, 1.0, v24
    v_rcp_f32 v25, v24
    s_nop 0
    v_mul_f32 v22, v22, v25
    v_mul_f32 v24, 0xbfb8aa3b, v23
    v_exp_f32 v24, v24
    s_nop 0
    v_add_f32 v24, 1.0, v24
    v_rcp_f32 v25, v24
    s_nop 0
    v_mul_f32 v23, v23, v25
    v_cvt_pk_bf16_f32 v8, v16, v17
    v_cvt_pk_bf16_f32 v9, v18, v19
    v_cvt_pk_bf16_f32 v10, v20, v21
    v_cvt_pk_bf16_f32 v11, v22, v23
    v_lshrrev_b32 v6, 2, v1
    v_lshlrev_b32 v6, 6, v6
    v_and_b32 v7, 1, v1
    v_lshl_add_u32 v6, v7, 5, v6
    v_bfe_u32 v7, v1, 1, 1
    v_lshl_add_u32 v6, v7, 3, v6
    s_mul_i32 s64, s68, 1088
    s_add_u32 s64, s64, 147456
    v_add_u32 v6, s64, v6
    ds_write_b64 v6, v[8:9]
    ds_write_b64 v6, v[10:11] offset:16
    v_mov_b32 v24, 156420
    v_mov_b32 v25, 1
    s_mov_b64 s[74:75], exec
    s_mov_b64 exec, 1
    ds_add_u32 v24, v25
    s_mov_b64 exec, s[74:75]
LAF_46:
    s_cmp_eq_u32 s95, 0
    s_cbranch_scc1 NOQ_47
    s_mov_b32 s32, s36
    s_and_b32 s33, s37, 0xffff
    s_mov_b32 s34, 4096
    s_mov_b32 s35, 0x20000
    s_lshl_b32 s64, s68, 10
    v_lshlrev_b32 v4, 3, v1
    buffer_load_dwordx2 v[8:9], v4, s[32:35], s64 offen
    buffer_load_dwordx2 v[10:11], v4, s[32:35], s64 offen offset:512
    s_lshl_b32 s64, s68, 12
    s_add_u32 s64, s64, 1769472
    v_lshlrev_b32 v5, 4, v1
    v_add_u32 v5, s64, v5
    v_lshrrev_b32 v6, 3, v1
    v_lshlrev_b32 v6, 6, v6
    v_and_b32 v7, 3, v1
    v_lshl_add_u32 v6, v7, 4, v6
    v_bfe_u32 v7, v1, 2, 1
    v_lshl_add_u32 v6, v7, 3, v6
    s_mul_i32 s64, s68, 1088
    s_add_u32 s64, s64, 147456
    v_add_u32 v6, s64, v6
    s_waitcnt vmcnt(0) lgkmcnt(0)
    s_add_u32 s4, s4, 0x9E3779B9
    v_lshlrev_b32 v16, 16, v8
    v_and_b32 v17, 0xffff0000, v8
    v_lshlrev_b32 v18, 16, v9
    v_and_b32 v19, 0xffff0000, v9
    v_lshlrev_b32 v20, 16, v10
    v_and_b32 v21, 0xffff0000, v10
    v_lshlrev_b32 v22, 16, v11
    v_and_b32 v23, 0xffff0000, v11
    v_readfirstlane_b32 s64, v16
    v_readfirstlane_b32 s65, v16
    s_nop 1
    v_pk_add_f32 v[28:29], v[16:17], s[64:65] neg_lo:[0,1] neg_hi:[0,1]
    v_pk_add_f32 v[30:31], v[18:19], s[64:65] neg_lo:[0,1] neg_hi:[0,1]
    v_pk_add_f32 v[32:33], v[20:21], s[64:65] neg_lo:[0,1] neg_hi:[0,1]
    v_pk_add_f32 v[34:35], v[22:23], s[64:65] neg_lo:[0,1] neg_hi:[0,1]
    v_pk_add_f32 v[26:27], v[28:29], v[30:31]
    v_pk_mul_f32 v[24:25], v[28:29], v[28:29]
    v_pk_add_f32 v[26:27], v[26:27], v[32:33]
    v_pk_fma_f32 v[24:25], v[30:31], v[30:31], v[24:25]
    v_pk_add_f32 v[26:27], v[26:27], v[34:35]
    v_pk_fma_f32 v[24:25], v[32:33], v[32:33], v[24:25]
    v_pk_fma_f32 v[24:25], v[34:35], v[34:35], v[24:25]
    v_add_f32 v25, v24, v25
    v_add_f32 v24, v26, v27
    s_nop 1
    v_add_f32_dpp v24, v24, v24 quad_perm:[1,0,3,2] row_mask:0xf bank_mask:0xf
    v_add_f32_dpp v25, v25, v25 quad_perm:[1,0,3,2] row_mask:0xf bank_mask:0xf
    s_nop 0
    v_add_f32_dpp v24, v24, v24 quad_perm:[2,3,0,1] row_mask:0xf bank_mask:0xf
    v_add_f32_dpp v25, v25, v25 quad_perm:[2,3,0,1] row_mask:0xf bank_mask:0xf
    s_nop 0
    v_add_f32_dpp v24, v24, v24 row_half_mirror row_mask:0xf bank_mask:0xf
    v_add_f32_dpp v25, v25, v25 row_half_mirror row_mask:0xf bank_mask:0xf
    s_nop 0
    v_add_f32_dpp v24, v24, v24 row_mirror row_mask:0xf bank_mask:0xf
    v_add_f32_dpp v25, v25, v25 row_mirror row_mask:0xf bank_mask:0xf
    s_nop 0
    v_mov_b32 v26, v24
    v_mov_b32 v27, v25
    s_nop 1
    v_permlane16_swap_b32 v24, v26
    v_permlane16_swap_b32 v25, v27
    s_nop 0
    v_add_f32 v24, v24, v26
    v_add_f32 v25, v25, v27
    v_mov_b32 v26, v24
    v_mov_b32 v27, v25
    s_nop 1
    v_permlane32_swap_b32 v24, v26
    v_permlane32_swap_b32 v25, v27
    s_nop 0
    v_add_f32 v24, v24, v26
    v_add_f32 v25, v25, v27
    v_mul_f32 v24, 0x3b000000, v24
    v_mul_f32 v25, 0x3b000000, v25
    v_fma_f32 v25, -v24, v24, v25
    v_add_f32 v24, s64, v24
    v_max_f32 v25, 0, v25
    v_cvt_pk_bf16_f32 v26, v24, v25
    v_lshlrev_b32 v24, 16, v26
    v_and_b32 v25, 0xffff0000, v26
    v_add_f32 v25, 0x3727c5ac, v25
    v_cvt_pk_bf16_f32 v26, v25, v25
    v_lshlrev_b32 v25, 16, v26
    v_sqrt_f32 v25, v25
    s_nop 0
    v_pk_add_f32 v[16:17], v[16:17], v[24:25] op_sel_hi:[1,0] neg_lo:[0,1] neg_hi:[0,1]
    v_pk_add_f32 v[18:19], v[18:19], v[24:25] op_sel_hi:[1,0] neg_lo:[0,1] neg_hi:[0,1]
    v_pk_add_f32 v[20:21], v[20:21], v[24:25] op_sel_hi:[1,0] neg_lo:[0,1] neg_hi:[0,1]
    v_pk_add_f32 v[22:23], v[22:23], v[24:25] op_sel_hi:[1,0] neg_lo:[0,1] neg_hi:[0,1]
    v_cvt_pk_bf16_f32 v26, v25, v25
    v_lshlrev_b32 v25, 16, v26
    v_rcp_f32 v26, v25
    v_cvt_pk_bf16_f32 v28, v16, v17
    v_lshlrev_b32 v16, 16, v28
    v_and_b32 v17, 0xffff0000, v28
    v_cvt_pk_bf16_f32 v28, v18, v19
    v_lshlrev_b32 v18, 16, v28
    v_and_b32 v19, 0xffff0000, v28
    v_cvt_pk_bf16_f32 v28, v20, v21
    v_lshlrev_b32 v20, 16, v28
    v_and_b32 v21, 0xffff0000, v28
    v_cvt_pk_bf16_f32 v28, v22, v23
    v_lshlrev_b32 v22, 16, v28
    v_and_b32 v23, 0xffff0000, v28
    v_pk_mul_f32 v[16:17], v[16:17], v[26:27] op_sel_hi:[1,0]
    v_pk_mul_f32 v[18:19], v[18:19], v[26:27] op_sel_hi:[1,0]
    v_pk_mul_f32 v[20:21], v[20:21], v[26:27] op_sel_hi:[1,0]
    v_pk_mul_f32 v[22:23], v[22:23], v[26:27] op_sel_hi:[1,0]
    v_cvt_pk_bf16_f32 v28, v16, v17
    v_lshlrev_b32 v16, 16, v28
    v_and_b32 v17, 0xffff0000, v28
    v_cvt_pk_bf16_f32 v28, v18, v19
    v_lshlrev_b32 v18, 16, v28
    v_and_b32 v19, 0xffff0000, v28
    v_cvt_pk_bf16_f32 v28, v20, v21
    v_lshlrev_b32 v20, 16, v28
    v_and_b32 v21, 0xffff0000, v28
    v_cvt_pk_bf16_f32 v28, v22, v23
    v_lshlrev_b32 v22, 16, v28
    v_and_b32 v23, 0xffff0000, v28
    v_mov_b32 v36, 156464
    s_mov_b32 s82, 0
W_48:
    ds_read_b32 v37, v36
    s_waitcnt lgkmcnt(0)
    v_readfirstlane_b32 s71, v37
    s_cmp_ge_u32 s71, 8
    s_cbranch_scc1 WD_49
    s_sleep 1
    s_add_u32 s82, s82, 1
    s_cmp_lt_u32 s82, 4000000
    s_cbranch_scc1 W_48
    s_branch L_END
WD_49:
    s_mov_b32 s82, 0
P_51:
    buffer_load_dwordx4 v[40:43], v5, s[8:11], 0 offen offset:0 sc1
    buffer_load_dwordx4 v[44:47], v5, s[8:11], 0 offen offset:1024 sc1
    buffer_load_dwordx4 v[48:51], v5, s[8:11], 0 offen offset:2048 sc1
    buffer_load_dwordx4 v[52:55], v5, s[8:11], 0 offen offset:3072 sc1
    s_waitcnt vmcnt(0)
    v_cmp_eq_u32 vcc, s4, v41
    v_cmp_eq_u32 s[72:73], s4, v43
    s_and_b64 vcc, vcc, s[72:73]
    v_cmp_eq_u32 s[72:73], s4, v45
    s_and_b64 vcc, vcc, s[72:73]
    v_cmp_eq_u32 s[72:73], s4, v47
    s_and_b64 vcc, vcc, s[72:73]
    v_cmp_eq_u32 s[72:73], s4, v49
    s_and_b64 vcc, vcc, s[72:73]
    v_cmp_eq_u32 s[72:73], s4, v51
    s_and_b64 vcc, vcc, s[72:73]
    v_cmp_eq_u32 s[72:73], s4, v53
    s_and_b64 vcc, vcc, s[72:73]
    v_cmp_eq_u32 s[72:73], s4, v55
    s_and_b64 vcc, vcc, s[72:73]
    s_cmp_eq_u64 vcc, exec
    s_cbranch_scc1 PD_50
    s_sleep 1
    s_add_u32 s82, s82, 1
    s_cmp_lt_u32 s82, 200000
    s_cbranch_scc1 P_51
    s_branch L_END
PD_50:
    v_lshlrev_b32 v56, 16, v48
    v_and_b32 v57, 0xffff0000, v48
    v_lshlrev_b32 v58, 16, v50
    v_and_b32 v59, 0xffff0000, v50
    v_lshlrev_b32 v60, 16, v52
    v_and_b32 v61, 0xffff0000, v52
    v_lshlrev_b32 v62, 16, v54
    v_and_b32 v63, 0xffff0000, v54
    v_pk_add_f32 v[56:57], v[56:57], 1.0 op_sel_hi:[1,0]
    v_pk_add_f32 v[58:59], v[58:59], 1.0 op_sel_hi:[1,0]
    v_pk_add_f32 v[60:61], v[60:61], 1.0 op_sel_hi:[1,0]
    v_pk_add_f32 v[62:63], v[62:63], 1.0 op_sel_hi:[1,0]
    v_cvt_pk_bf16_f32 v24, v56, v57
    v_lshlrev_b32 v56, 16, v24
    v_and_b32 v57, 0xffff0000, v24
    v_cvt_pk_bf16_f32 v24, v58, v59
    v_lshlrev_b32 v58, 16, v24
    v_and_b32 v59, 0xffff0000, v24
    v_cvt_pk_bf16_f32 v24, v60, v61
    v_lshlrev_b32 v60, 16, v24
    v_and_b32 v61, 0xffff0000, v24
    v_cvt_pk_bf16_f32 v24, v62, v63
    v_lshlrev_b32 v62, 16, v24
    v_and_b32 v63, 0xffff0000, v24
    v_pk_mul_f32 v[16:17], v[16:17], v[56:57]
    v_pk_mul_f32 v[18:19], v[18:19], v[58:59]
    v_pk_mul_f32 v[20:21], v[20:21], v[60:61]
    v_pk_mul_f32 v[22:23], v[22:23], v[62:63]
    v_cvt_pk_bf16_f32 v24, v16, v17
    v_lshlrev_b32 v16, 16, v24
    v_and_b32 v17, 0xffff0000, v24
    v_cvt_pk_bf16_f32 v24, v18, v19
    v_lshlrev_b32 v18, 16, v24
    v_and_b32 v19, 0xffff0000, v24
    v_cvt_pk_bf16_f32 v24, v20, v21
    v_lshlrev_b32 v20, 16, v24
    v_and_b32 v21, 0xffff0000, v24
    v_cvt_pk_bf16_f32 v24, v22, v23
    v_lshlrev_b32 v22, 16, v24
    v_and_b32 v23, 0xffff0000, v24
    v_lshlrev_b32 v56, 16, v40
    v_and_b32 v57, 0xffff0000, v40
    v_lshlrev_b32 v58, 16, v42
    v_and_b32 v59, 0xffff0000, v42
    v_lshlrev_b32 v60, 16, v44
    v_and_b32 v61, 0xffff0000, v44
    v_lshlrev_b32 v62, 16, v46
    v_and_b32 v63, 0xffff0000, v46
    v_pk_add_f32 v[16:17], v[16:17], v[56:57]
    v_pk_add_f32 v[18:19], v[18:19], v[58:59]
    v_pk_add_f32 v[20:21], v[20:21], v[60:61]
    v_pk_add_f32 v[22:23], v[22:23], v[62:63]
    v_cvt_pk_bf16_f32 v8, v16, v17
    v_cvt_pk_bf16_f32 v9, v18, v19
    v_cvt_pk_bf16_f32 v10, v20, v21
    v_cvt_pk_bf16_f32 v11, v22, v23
    ds_write_b64 v6, v[8:9]
    ds_write_b64 v6, v[10:11] offset:512
    v_mov_b32 v24, 156420
    v_mov_b32 v25, 1
    s_mov_b64 s[74:75], exec
    s_mov_b64 exec, 1
    ds_add_u32 v24, v25
    s_mov_b64 exec, s[74:75]
    v_mov_b32 v24, 156468
    s_mov_b32 s82, 0
W_52:
    ds_read_b32 v25, v24
    s_waitcnt lgkmcnt(0)
    v_readfirstlane_b32 s71, v25
    s_cmp_ge_u32 s71, 4
    s_cbranch_scc1 WD_53
    s_sleep 1
    s_add_u32 s82, s82, 1
    s_cmp_lt_u32 s82, 4000000
    s_cbranch_scc1 W_52
    s_branch L_END
WD_53:
    s_sub_u32 s4, s4, 0x9E3779B9
NOQ_47:
    v_lshrrev_b32 v5, 1, v3
    v_xor_b32 v5, v5, v2
    v_lshlrev_b32 v5, 5, v5
    v_and_b32 v6, 1, v1
    v_lshl_add_u32 v5, v6, 4, v5
    v_lshl_add_u32 v7, v2, 10, v5
    v_lshl_add_u32 v5, v2, 8, v5
    v_xor_b32 v6, 128, v5
    v_xor_b32 v10, 128, v7
    s_waitcnt vmcnt(0)
    v_mov_b32 v24, 156416
    v_mov_b32 v25, 1
    s_mov_b64 s[74:75], exec
    s_mov_b64 exec, 1
    ds_add_u32 v24, v25
    s_mov_b64 exec, s[74:75]
    s_waitcnt lgkmcnt(0)
    s_add_u32 s4, s4, 0x9E3779B9
    s_sub_u32 s69, s78, 4
    s_cmp_eq_u32 s95, 1
    s_cselect_b32 s69, 0, s69
    v_mov_b32 v24, 156432
    s_mov_b32 s82, 0
W_54:
    ds_read_b32 v25, v24
    s_waitcnt lgkmcnt(0)
    v_readfirstlane_b32 s71, v25
    s_cmp_ge_u32 s71, s69
    s_cbranch_scc1 WD_55
    s_sleep 1
    s_add_u32 s82, s82, 1
    s_cmp_lt_u32 s82, 4000000
    s_cbranch_scc1 W_54
    s_branch L_END
WD_55:
    s_mov_b32 s69, s68
    s_lshl_b32 s65, s69, 13
    s_add_u32 s64, s94, s65
    s_mov_b32 m0, s65
    s_add_u32 s65, s65, 4096
    buffer_load_dwordx4 v5, s[16:19], s64 offen offset:0 nt lds
    buffer_load_dwordx4 v6, s[16:19], s64 offen offset:1024 nt lds
    buffer_load_dwordx4 v6, s[16:19], s64 offen offset:2048 nt lds
    buffer_load_dwordx4 v5, s[16:19], s64 offen offset:3072 nt lds
    s_mov_b32 m0, s65
    s_add_u32 s64, s64, 4096
    buffer_load_dwordx4 v5, s[16:19], s64 offen offset:0 nt lds
    buffer_load_dwordx4 v6, s[16:19], s64 offen offset:1024 nt lds
    buffer_load_dwordx4 v6, s[16:19], s64 offen offset:2048 nt lds
    buffer_load_dwordx4 v5, s[16:19], s64 offen offset:3072 nt lds
    s_add_u32 s69, s68, 4
    s_cmp_lt_u32 s69, s78
    s_cbranch_scc0 V1_58
    s_lshl_b32 s65, s69, 13
    s_add_u32 s64, s94, s65
    s_mov_b32 m0, s65
    s_add_u32 s65, s65, 4096
    buffer_load_dwordx4 v5, s[16:19], s64 offen offset:0 nt lds
    buffer_load_dwordx4 v6, s[16:19], s64 offen offset:1024 nt lds
    buffer_load_dwordx4 v6, s[16:19], s64 offen offset:2048 nt lds
    buffer_load_dwordx4 v5, s[16:19], s64 offen offset:3072 nt lds
    s_mov_b32 m0, s65
    s_add_u32 s64, s64, 4096
    buffer_load_dwordx4 v5, s[16:19], s64 offen offset:0 nt lds
    buffer_load_dwordx4 v6, s[16:19], s64 offen offset:1024 nt lds
    buffer_load_dwordx4 v6, s[16:19], s64 offen offset:2048 nt lds
    buffer_load_dwordx4 v5, s[16:19], s64 offen offset:3072 nt lds
    s_add_u32 s69, s68, 8
    s_cmp_lt_u32 s69, s78
    s_cbranch_scc0 V2_57
    s_lshl_b32 s65, s69, 13
    s_add_u32 s64, s94, s65
    s_mov_b32 m0, s65
    s_add_u32 s65, s65, 4096
    buffer_load_dwordx4 v5, s[16:19], s64 offen offset:0 nt lds
    buffer_load_dwordx4 v6, s[16:19], s64 offen offset:1024 nt lds
    buffer_load_dwordx4 v6, s[16:19], s64 offen offset:2048 nt lds
    buffer_load_dwordx4 v5, s[16:19], s64 offen offset:3072 nt lds
    s_mov_b32 m0, s65
    s_add_u32 s64, s64, 4096
    buffer_load_dwordx4 v5, s[16:19], s64 offen offset:0 nt lds
    buffer_load_dwordx4 v6, s[16:19], s64 offen offset:1024 nt lds
    buffer_load_dwordx4 v6, s[16:19], s64 offen offset:2048 nt lds
    buffer_load_dwordx4 v5, s[16:19], s64 offen offset:3072 nt lds
    s_lshl_b32 s66, 1, s68
    s_waitcnt vmcnt(16)
    v_mov_b32 v24, 156448
    v_mov_b32 v25, s66
    s_mov_b64 s[74:75], exec
    s_mov_b64 exec, 1
    ds_or_b32 v24, v25
    s_mov_b64 exec, s[74:75]
    s_lshl_b32 s66, s66, 4
    s_waitcnt vmcnt(8)
    v_mov_b32 v24, 156448
    v_mov_b32 v25, s66
    s_mov_b64 s[74:75], exec
    s_mov_b64 exec, 1
    ds_or_b32 v24, v25
    s_mov_b64 exec, s[74:75]
    s_lshl_b32 s66, s66, 4
    s_waitcnt vmcnt(0)
    v_mov_b32 v24, 156448
    v_mov_b32 v25, s66
    s_mov_b64 s[74:75], exec
    s_mov_b64 exec, 1
    ds_or_b32 v24, v25
    s_mov_b64 exec, s[74:75]
    s_branch VD_56
V2_57:
    s_lshl_b32 s66, 1, s68
    s_waitcnt vmcnt(8)
    v_mov_b32 v24, 156448
    v_mov_b32 v25, s66
    s_mov_b64 s[74:75], exec
    s_mov_b64 exec, 1
    ds_or_b32 v24, v25
    s_mov_b64 exec, s[74:75]
    s_lshl_b32 s66, s66, 4
    s_waitcnt vmcnt(0)
    v_mov_b32 v24, 156448
    v_mov_b32 v25, s66
    s_mov_b64 s[74:75], exec
    s_mov_b64 exec, 1
    ds_or_b32 v24, v25
    s_mov_b64 exec, s[74:75]
    s_branch VD_56
V1_58:
    s_lshl_b32 s66, 1, s68
    s_waitcnt vmcnt(0)
    v_mov_b32 v24, 156448
    v_mov_b32 v25, s66
    s_mov_b64 s[74:75], exec
    s_mov_b64 exec, 1
    ds_or_b32 v24, v25
    s_mov_b64 exec, s[74:75]
VD_56:
    s_cmp_eq_u32 s81, 0
    s_cbranch_scc1 L_END
    s_lshl_b32 s64, s68, 3
    s_lshl_b32 s65, s64, 10
    s_add_u32 s65, s65, 114688
    s_lshl_b32 s66, s64, 12
    s_lshl_b32 s67, s92, 17
    s_add_u32 s66, s66, s67
    s_lshl_b32 s67, s93, 8
    s_add_u32 s66, s66, s67
    s_mov_b32 m0, s65
    s_add_u32 s65, s65, 1024
    buffer_load_dwordx4 v7, s[24:27], s66 offen nt lds
    s_add_u32 s66, s66, 4096
    s_mov_b32 m0, s65
    s_add_u32 s65, s65, 1024
    buffer_load_dwordx4 v7, s[24:27], s66 offen nt lds
    s_add_u32 s66, s66, 4096
    s_mov_b32 m0, s65
    s_add_u32 s65, s65, 1024
    buffer_load_dwordx4 v10, s[24:27], s66 offen nt lds
    s_add_u32 s66, s66, 4096
    s_mov_b32 m0, s65
    s_add_u32 s65, s65, 1024
    buffer_load_dwordx4 v10, s[24:27], s66 offen nt lds
    s_add_u32 s66, s66, 4096
    s_mov_b32 m0, s65
    s_add_u32 s65, s65, 1024
    buffer_load_dwordx4 v7, s[24:27], s66 offen nt lds
    s_add_u32 s66, s66, 4096
    s_mov_b32 m0, s65
    s_add_u32 s65, s65, 1024
    buffer_load_dwordx4 v7, s[24:27], s66 offen nt lds
    s_add_u32 s66, s66, 4096
    s_mov_b32 m0, s65
    s_add_u32 s65, s65, 1024
    buffer_load_dwordx4 v10, s[24:27], s66 offen nt lds
    s_add_u32 s66, s66, 4096
    s_mov_b32 m0, s65
    s_add_u32 s65, s65, 1024
    buffer_load_dwordx4 v10, s[24:27], s66 offen nt lds
    s_add_u32 s66, s66, 4096
    s_waitcnt vmcnt(0)
    v_mov_b32 v24, 156456
    v_mov_b32 v25, 1
    s_mov_b64 s[74:75], exec
    s_mov_b64 exec, 1
    ds_add_u32 v24, v25
    s_mov_b64 exec, s[74:75]
L_S_LATE:
    s_cmp_eq_u32 s81, 0
    s_cbranch_scc1 L_END
    s_setprio 0
    v_mov_b32 v58, 0
    s_lshl_b32 s70, s3, 6
    v_add_u32 v4, s70, v1
    s_mul_i32 s64, s92, 14336
    s_add_u32 s64, s64, 262144
    s_mul_i32 s65, s92, 448
    s_add_u32 s65, s65, 116736
    s_cmp_lt_u32 s3, 14
    s_cselect_b32 s64, s64, s65
    v_lshlrev_b32 v5, 4, v4
    v_add_u32 v5, s64, v5
    v_lshrrev_b32 v6, 5, v4
    s_cmp_lt_u32 s3, 14
    s_cbranch_scc1 LW_59
    v_mov_b32 v6, v1
LW_59:
    v_mul_u32_u24 v7, 37, v6
    v_lshrrev_b32 v7, 8, v7
    v_add_u32 v6, v6, v7
    s_cmp_lt_u32 s3, 14
    s_cbranch_scc1 LW_60
    v_lshlrev_b32 v6, 3, v6
    v_add_u32 v6, 8704, v6
    s_branch LW_61
LW_60:
    v_mul_u32_u24 v6, 272, v6
    v_and_b32 v7, 31, v4
    v_lshl_add_u32 v6, v7, 3, v6
    v_add_u32 v6, 0, v6
LW_61:
    s_cmp_ge_u32 s3, 8
    s_cbranch_scc1 LNW_62
    v_mov_b32 v8, 156456
    s_mov_b32 s82, 0
W_63:
    ds_read_b32 v9, v8
    s_waitcnt lgkmcnt(0)
    v_readfirstlane_b32 s71, v9
    s_cmp_ge_u32 s71, 4
    s_cbranch_scc1 WD_64
    s_sleep 1
    s_add_u32 s82, s82, 1
    s_cmp_lt_u32 s82, 4000000
    s_cbranch_scc1 W_63
    s_branch L_END
WD_64:
    v_lshrrev_b32 v12, 2, v3
    v_lshl_add_u32 v13, v2, 3, v12
    v_and_b32 v14, 1, v2
    v_lshl_add_u32 v12, v14, 2, v12
    v_xor_b32 v12, s3, v12
    v_lshlrev_b32 v12, 5, v12
    v_lshl_add_u32 v12, v13, 8, v12
    v_and_b32 v14, 3, v1
    v_lshl_add_u32 v12, v14, 3, v12
    v_add_u32 v12, 114688, v12
    ds_read_b64_tr_b16 v[32:33], v12 offset:0
    ds_read_b64_tr_b16 v[34:35], v12 offset:1024
    ds_read_b64_tr_b16 v[36:37], v12 offset:8192
    ds_read_b64_tr_b16 v[38:39], v12 offset:9216
    ds_read_b64_tr_b16 v[40:41], v12 offset:16384
    ds_read_b64_tr_b16 v[42:43], v12 offset:17408
    ds_read_b64_tr_b16 v[44:45], v12 offset:24576
    ds_read_b64_tr_b16 v[46:47], v12 offset:25600
    v_mul_u32_u24 v56, 272, v3
    v_lshl_add_u32 v56, v2, 4, v56
    v_add_u32 v56, 0, v56
    v_lshlrev_b32 v57, 3, v3
    v_add_u32 v57, 8704, v57
    s_lshl_b32 s64, s93, 3
    s_add_u32 s64, s64, s3
    s_lshl_b32 s64, s64, 5
    s_add_u32 s64, s64, s92
    s_lshl_b32 s64, s64, 8
    s_add_u32 s64, s64, 786432
    v_bfe_u32 v58, v1, 3, 1
    v_lshlrev_b32 v58, 6, v58
    v_lshl_add_u32 v58, v2, 4, v58
    v_and_b32 v59, 1, v1
    v_lshl_add_u32 v58, v59, 7, v58
    v_add_u32 v58, s64, v58
    v_mov_b32 v61, s4
    v_mov_b32 v63, s4
    v_cmp_eq_u32 s[88:89], 1, v59
    v_and_b32 v14, 6, v1
    v_cmp_eq_u32 s[86:87], 0, v14
LNW_62:
    s_cmp_eq_u32 s3, 15
    s_cbranch_scc1 LZ_65
    s_mov_b64 s[98:99], exec
    s_cmp_lg_u32 s3, 14
    s_cbranch_scc1 LF_67
    s_mov_b32 exec_lo, 0x0fffffff
    s_mov_b32 exec_hi, 0
LF_67:
    s_mov_b32 s82, 0
P_69:
    buffer_load_dwordx4 v[8:11], v5, s[8:11], 0 offen offset:0 sc1
    s_waitcnt vmcnt(0)
    v_cmp_eq_u32 vcc, s4, v9
    v_cmp_eq_u32 s[72:73], s4, v11
    s_and_b64 vcc, vcc, s[72:73]
    s_cmp_eq_u64 vcc, exec
    s_cbranch_scc1 PD_68
    s_add_u32 s82, s82, 1
    s_cmp_lt_u32 s82, 200000
    s_cbranch_scc1 P_69
    s_branch L_END
PD_68:
    v_mov_b32 v9, v10
    v_mov_b32 v12, 156452
    s_mov_b32 s82, 0
W_70:
    ds_read_b32 v13, v12
    s_waitcnt lgkmcnt(0)
    v_readfirstlane_b32 s71, v13
    s_cmp_ge_u32 s71, 8
    s_cbranch_scc1 WD_71
    s_add_u32 s82, s82, 1
    s_cmp_lt_u32 s82, 4000000
    s_cbranch_scc1 W_70
    s_branch L_END
WD_71:
    ds_write_b64 v6, v[8:9]
    s_mov_b64 exec, s[98:99]
    s_branch LZD_66
LZ_65:
    v_mov_b32 v12, 156452
    s_mov_b32 s82, 0
W_72:
    ds_read_b32 v13, v12
    s_waitcnt lgkmcnt(0)
    v_readfirstlane_b32 s71, v13
    s_cmp_ge_u32 s71, 8
    s_cbranch_scc1 WD_73
    s_sleep 1
    s_add_u32 s82, s82, 1
    s_cmp_lt_u32 s82, 4000000
    s_cbranch_scc1 W_72
    s_branch L_END
WD_73:
    v_lshlrev_b32 v6, 3, v2
    v_add_u32 v6, 7, v6
    v_mul_u32_u24 v7, 272, v6
    v_lshl_add_u32 v7, v3, 4, v7
    v_add_u32 v7, 0, v7
    v_mov_b32 v12, 0
    v_mov_b32 v13, 0
    v_mov_b32 v14, 0
    v_mov_b32 v15, 0
    ds_write_b128 v7, v[12:15]
    v_lshlrev_b32 v6, 3, v6
    v_add_u32 v6, 8704, v6
    v_mov_b32 v12, 0xff800000
    ds_write_b64 v6, v[12:13]
LZD_66:
    s_waitcnt lgkmcnt(0)
    s_barrier
    s_cmp_ge_u32 s3, 8
    s_cbranch_scc1 L_END
    ds_read_b64 v[8:9], v57
    ds_read_b64 v[10:11], v57 offset:128
    ds_read_b128 v[64:67], v56 offset:0
    ds_read_b128 v[68:71], v56 offset:64
    ds_read_b128 v[72:75], v56 offset:128
    ds_read_b128 v[76:79], v56 offset:192
    ds_read_b128 v[80:83], v56 offset:4352
    ds_read_b128 v[84:87], v56 offset:4416
    ds_read_b128 v[88:91], v56 offset:4480
    ds_read_b128 v[92:95], v56 offset:4544
    s_waitcnt lgkmcnt(8)
    v_mov_b32 v12, v8
    v_mov_b32 v13, v10
    s_nop 0
    v_max_f32_dpp v12, v12, v12 quad_perm:[1,0,3,2] row_mask:0xf bank_mask:0xf
    v_max_f32_dpp v13, v13, v13 quad_perm:[1,0,3,2] row_mask:0xf bank_mask:0xf
    s_nop 0
    v_max_f32_dpp v12, v12, v12 quad_perm:[2,3,0,1] row_mask:0xf bank_mask:0xf
    v_max_f32_dpp v13, v13, v13 quad_perm:[2,3,0,1] row_mask:0xf bank_mask:0xf
    s_nop 0
    v_max_f32_dpp v12, v12, v12 row_half_mirror row_mask:0xf bank_mask:0xf
    v_max_f32_dpp v13, v13, v13 row_half_mirror row_mask:0xf bank_mask:0xf
    s_nop 0
    v_sub_f32 v8, v8, v12
    v_sub_f32 v10, v10, v13
    v_exp_f32 v8, v8
    v_exp_f32 v10, v10
    s_waitcnt lgkmcnt(0)
    v_mfma_f32_16x16x32_bf16 v[16:19], v[32:35], v[64:67], 0
    v_mfma_f32_16x16x32_bf16 v[20:23], v[32:35], v[80:83], 0
    v_mfma_f32_16x16x32_bf16 v[16:19], v[36:39], v[68:71], v[16:19]
    v_mfma_f32_16x16x32_bf16 v[20:23], v[36:39], v[84:87], v[20:23]
    v_mfma_f32_16x16x32_bf16 v[16:19], v[40:43], v[72:75], v[16:19]
    v_mfma_f32_16x16x32_bf16 v[20:23], v[40:43], v[88:91], v[20:23]
    v_mfma_f32_16x16x32_bf16 v[16:19], v[44:47], v[76:79], v[16:19]
    v_mfma_f32_16x16x32_bf16 v[20:23], v[44:47], v[92:95], v[20:23]
    v_mul_f32 v8, v8, v9
    v_mul_f32 v10, v10, v11
    v_mov_b32 v12, v8
    v_mov_b32 v13, v10
    s_nop 0
    v_add_f32_dpp v12, v12, v12 quad_perm:[1,0,3,2] row_mask:0xf bank_mask:0xf
    v_add_f32_dpp v13, v13, v13 quad_perm:[1,0,3,2] row_mask:0xf bank_mask:0xf
    s_nop 0
    v_add_f32_dpp v12, v12, v12 quad_perm:[2,3,0,1] row_mask:0xf bank_mask:0xf
    v_add_f32_dpp v13, v13, v13 quad_perm:[2,3,0,1] row_mask:0xf bank_mask:0xf
    s_nop 0
    v_add_f32_dpp v12, v12, v12 row_half_mirror row_mask:0xf bank_mask:0xf
    v_add_f32_dpp v13, v13, v13 row_half_mirror row_mask:0xf bank_mask:0xf
    s_nop 0
    v_rcp_f32 v12, v12
    v_rcp_f32 v13, v13
    s_nop 0
    v_mul_f32 v8, v8, v12
    v_mul_f32 v10, v10, v13
    s_nop 0
    v_pk_mul_f32 v[16:17], v[16:17], v[8:9] op_sel_hi:[1,0]
    v_pk_mul_f32 v[18:19], v[18:19], v[8:9] op_sel_hi:[1,0]
    v_pk_mul_f32 v[20:21], v[20:21], v[10:11] op_sel_hi:[1,0]
    v_pk_mul_f32 v[22:23], v[22:23], v[10:11] op_sel_hi:[1,0]
    s_nop 0
    v_add_f32_dpp v16, v16, v16 quad_perm:[1,0,3,2] row_mask:0xf bank_mask:0xf
    v_add_f32_dpp v17, v17, v17 quad_perm:[1,0,3,2] row_mask:0xf bank_mask:0xf
    v_add_f32_dpp v18, v18, v18 quad_perm:[1,0,3,2] row_mask:0xf bank_mask:0xf
    v_add_f32_dpp v19, v19, v19 quad_perm:[1,0,3,2] row_mask:0xf bank_mask:0xf
    v_add_f32_dpp v20, v20, v20 quad_perm:[1,0,3,2] row_mask:0xf bank_mask:0xf
    v_add_f32_dpp v21, v21, v21 quad_perm:[1,0,3,2] row_mask:0xf bank_mask:0xf
    v_add_f32_dpp v22, v22, v22 quad_perm:[1,0,3,2] row_mask:0xf bank_mask:0xf
    v_add_f32_dpp v23, v23, v23 quad_perm:[1,0,3,2] row_mask:0xf bank_mask:0xf
    v_add_f32_dpp v16, v16, v16 quad_perm:[2,3,0,1] row_mask:0xf bank_mask:0xf
    v_add_f32_dpp v17, v17, v17 quad_perm:[2,3,0,1] row_mask:0xf bank_mask:0xf
    v_add_f32_dpp v18, v18, v18 quad_perm:[2,3,0,1] row_mask:0xf bank_mask:0xf
    v_add_f32_dpp v19, v19, v19 quad_perm:[2,3,0,1] row_mask:0xf bank_mask:0xf
    v_add_f32_dpp v20, v20, v20 quad_perm:[2,3,0,1] row_mask:0xf bank_mask:0xf
    v_add_f32_dpp v21, v21, v21 quad_perm:[2,3,0,1] row_mask:0xf bank_mask:0xf
    v_add_f32_dpp v22, v22, v22 quad_perm:[2,3,0,1] row_mask:0xf bank_mask:0xf
    v_add_f32_dpp v23, v23, v23 quad_perm:[2,3,0,1] row_mask:0xf bank_mask:0xf
    v_add_f32_dpp v16, v16, v16 row_half_mirror row_mask:0xf bank_mask:0xf
    v_add_f32_dpp v17, v17, v17 row_half_mirror row_mask:0xf bank_mask:0xf
    v_add_f32_dpp v18, v18, v18 row_half_mirror row_mask:0xf bank_mask:0xf
    v_add_f32_dpp v19, v19, v19 row_half_mirror row_mask:0xf bank_mask:0xf
    v_add_f32_dpp v20, v20, v20 row_half_mirror row_mask:0xf bank_mask:0xf
    v_add_f32_dpp v21, v21, v21 row_half_mirror row_mask:0xf bank_mask:0xf
    v_add_f32_dpp v22, v22, v22 row_half_mirror row_mask:0xf bank_mask:0xf
    v_add_f32_dpp v23, v23, v23 row_half_mirror row_mask:0xf bank_mask:0xf
    v_cndmask_b32 v24, v16, v20, s[88:89]
    v_cndmask_b32 v25, v17, v21, s[88:89]
    v_cndmask_b32 v26, v18, v22, s[88:89]
    v_cndmask_b32 v27, v19, v23, s[88:89]
    v_cvt_pk_bf16_f32 v60, v24, v25
    v_cvt_pk_bf16_f32 v62, v26, v27
    s_mov_b64 exec, s[86:87]
    buffer_store_dwordx4 v[60:63], v58, s[8:11], 0 offen sc1
    s_mov_b64 exec, -1
    s_branch L_END
L_T:
    s_mov_b32 s20, s56
    s_and_b32 s21, s57, 0xffff
    s_mov_b32 s22, 3145728
    s_mov_b32 s23, 0x20000
    s_mov_b32 s28, s54
    s_and_b32 s29, s55, 0xffff
    s_mov_b32 s30, 4096
    s_mov_b32 s31, 0x20000
    s_mov_b32 s32, s36
    s_and_b32 s33, s37, 0xffff
    s_mov_b32 s34, 4096
    s_mov_b32 s35, 0x20000
    s_mov_b32 s24, s58
    s_and_b32 s25, s59, 0xffff
    s_mov_b32 s26, 4096
    s_mov_b32 s27, 0x20000
    s_cmp_ge_u32 s3, 12
    s_cbranch_scc1 L_T_STREAM
    s_cmp_lg_u32 s3, 10
    s_cbranch_scc1 T1_74
    v_lshlrev_b32 v4, 2, v1
    v_add_u32 v4, 160512, v4
    v_mov_b32 v5, 0
    v_cmp_gt_u32 vcc, 16, v1
    s_and_saveexec_b64 s[72:73], vcc
    ds_write_b32 v4, v5
    s_mov_b64 exec, s[72:73]
    s_waitcnt lgkmcnt(0)
T1_74:
    s_barrier
    s_cmp_ge_u32 s6, 16
    s_cbranch_scc1 T2_75
    s_lshl_b32 s84, s6, 7
    s_lshl_b32 s85, s6, 8
    s_add_u32 s85, s85, 1769472
    s_cmp_ge_u32 s3, 8
    s_cbranch_scc1 Q8_76
    v_lshrrev_b32 v4, 3, v1
    v_mul_u32_u24 v4, 6144, v4
    v_bfe_u32 v5, v1, 1, 2
    v_bfe_u32 v6, v1, 4, 2
    v_xor_b32 v5, v5, v6
    v_lshl_add_u32 v4, v5, 5, v4
    v_and_b32 v5, 1, v1
    v_lshl_add_u32 v4, v5, 4, v4
    s_lshl_b32 s65, s3, 13
    s_mul_i32 s66, s3, 393216
    s_add_u32 s66, s66, s84
    s_mov_b32 m0, s65
    s_add_u32 s65, s65, 1024
    buffer_load_dwordx4 v4, s[20:23], s66 offen nt lds
    s_add_u32 s66, s66, 49152
    s_mov_b32 m0, s65
    s_add_u32 s65, s65, 1024
    buffer_load_dwordx4 v4, s[20:23], s66 offen nt lds
    s_add_u32 s66, s66, 49152
    s_mov_b32 m0, s65
    s_add_u32 s65, s65, 1024
    buffer_load_dwordx4 v4, s[20:23], s66 offen nt lds
    s_add_u32 s66, s66, 49152
    s_mov_b32 m0, s65
    s_add_u32 s65, s65, 1024
    buffer_load_dwordx4 v4, s[20:23], s66 offen nt lds
    s_add_u32 s66, s66, 49152
    s_mov_b32 m0, s65
    s_add_u32 s65, s65, 1024
    buffer_load_dwordx4 v4, s[20:23], s66 offen nt lds
    s_add_u32 s66, s66, 49152
    s_mov_b32 m0, s65
    s_add_u32 s65, s65, 1024
    buffer_load_dwordx4 v4, s[20:23], s66 offen nt lds
    s_add_u32 s66, s66, 49152
    s_mov_b32 m0, s65
    s_add_u32 s65, s65, 1024
    buffer_load_dwordx4 v4, s[20:23], s66 offen nt lds
    s_add_u32 s66, s66, 49152
    s_mov_b32 m0, s65
    s_add_u32 s65, s65, 1024
    buffer_load_dwordx4 v4, s[20:23], s66 offen nt lds
    s_add_u32 s66, s66, 49152
    s_load_dword s4, s[62:63], 0
    s_waitcnt vmcnt(0)
    v_mov_b32 v8, 160560
    v_mov_b32 v9, 1
    s_mov_b64 s[74:75], exec
    s_mov_b64 exec, 1
    ds_add_u32 v8, v9
    s_mov_b64 exec, s[74:75]
    s_waitcnt lgkmcnt(0)
    s_add_u32 s4, s4, 0x9E3779B9
    s_cmp_ge_u32 s3, 4
    s_cbranch_scc1 Q4_77
    s_mov_b32 s66, 0
    v_lshrrev_b32 v4, 2, v3
    v_lshl_add_u32 v4, v2, 2, v4
    v_bfe_u32 v5, v4, 1, 2
    s_and_b32 s65, s3, 3
    v_xor_b32 v5, s65, v5
    v_lshlrev_b32 v4, 7, v4
    v_lshl_add_u32 v4, v5, 5, v4
    v_and_b32 v5, 3, v1
    v_lshl_add_u32 v4, v5, 3, v4
    v_add_u32 v7, s66, v4
    v_and_b32 v5, 3, v1
    v_mul_u32_u24 v6, 1088, v5
    v_lshl_add_u32 v6, v2, 4, v6
    v_add_u32 v6, 155648, v6
    v_mov_b32 v8, 160560
    s_mov_b32 s82, 0
W_78:
    ds_read_b32 v9, v8
    s_waitcnt lgkmcnt(0)
    v_readfirstlane_b32 s71, v9
    s_cmp_ge_u32 s71, 8
    s_cbranch_scc1 WD_79
    s_sleep 1
    s_add_u32 s82, s82, 1
    s_cmp_lt_u32 s82, 4000000
    s_cbranch_scc1 W_78
    s_branch L_END
WD_79:
    ds_read_b64_tr_b16 v[32:33], v7 offset:0
    ds_read_b64_tr_b16 v[34:35], v7 offset:2048
    ds_read_b64_tr_b16 v[36:37], v7 offset:4096
    ds_read_b64_tr_b16 v[38:39], v7 offset:6144
    ds_read_b64_tr_b16 v[40:41], v7 offset:8192
    ds_read_b64_tr_b16 v[42:43], v7 offset:10240
    ds_read_b64_tr_b16 v[44:45], v7 offset:12288
    ds_read_b64_tr_b16 v[46:47], v7 offset:14336
    ds_read_b64_tr_b16 v[48:49], v7 offset:16384
    ds_read_b64_tr_b16 v[50:51], v7 offset:18432
    ds_read_b64_tr_b16 v[52:53], v7 offset:20480
    ds_read_b64_tr_b16 v[54:55], v7 offset:22528
    ds_read_b64_tr_b16 v[56:57], v7 offset:24576
    ds_read_b64_tr_b16 v[58:59], v7 offset:26624
    ds_read_b64_tr_b16 v[60:61], v7 offset:28672
    ds_read_b64_tr_b16 v[62:63], v7 offset:30720
    ds_read_b64_tr_b16 v[64:65], v7 offset:32768
    ds_read_b64_tr_b16 v[66:67], v7 offset:34816
    ds_read_b64_tr_b16 v[68:69], v7 offset:36864
    ds_read_b64_tr_b16 v[70:71], v7 offset:38912
    ds_read_b64_tr_b16 v[72:73], v7 offset:40960
    ds_read_b64_tr_b16 v[74:75], v7 offset:43008
    ds_read_b64_tr_b16 v[76:77], v7 offset:45056
    ds_read_b64_tr_b16 v[78:79], v7 offset:47104
    ds_read_b64_tr_b16 v[80:81], v7 offset:49152
    ds_read_b64_tr_b16 v[82:83], v7 offset:51200
    ds_read_b64_tr_b16 v[84:85], v7 offset:53248
    ds_read_b64_tr_b16 v[86:87], v7 offset:55296
    ds_read_b64_tr_b16 v[88:89], v7 offset:57344
    ds_read_b64_tr_b16 v[90:91], v7 offset:59392
    ds_read_b64_tr_b16 v[92:93], v7 offset:61440
    ds_read_b64_tr_b16 v[94:95], v7 offset:63488
    v_mov_b32 v8, 160516
    s_mov_b32 s82, 0
W_80:
    ds_read_b32 v9, v8
    s_waitcnt lgkmcnt(0)
    v_readfirstlane_b32 s71, v9
    s_cmp_ge_u32 s71, 4
    s_cbranch_scc1 WD_81
    s_sleep 1
    s_add_u32 s82, s82, 1
    s_cmp_lt_u32 s82, 4000000
    s_cbranch_scc1 W_80
    s_branch L_END
WD_81:
    ds_read_b128 v[8:11], v6 offset:0
    ds_read_b128 v[12:15], v6 offset:64
    ds_read_b128 v[16:19], v6 offset:128
    ds_read_b128 v[20:23], v6 offset:192
    ds_read_b128 v[112:115], v6 offset:256
    ds_read_b128 v[116:119], v6 offset:320
    ds_read_b128 v[120:123], v6 offset:384
    ds_read_b128 v[28:31], v6 offset:448
    s_waitcnt lgkmcnt(4)
    v_mfma_f32_16x16x32_bf16 v[24:27], v[32:35], v[8:11], 0
    v_mfma_f32_16x16x32_bf16 v[24:27], v[36:39], v[12:15], v[24:27]
    v_mfma_f32_16x16x32_bf16 v[24:27], v[40:43], v[16:19], v[24:27]
    v_mfma_f32_16x16x32_bf16 v[24:27], v[44:47], v[20:23], v[24:27]
    ds_read_b128 v[8:11], v6 offset:512
    ds_read_b128 v[12:15], v6 offset:576
    ds_read_b128 v[16:19], v6 offset:640
    ds_read_b128 v[20:23], v6 offset:704
    s_waitcnt lgkmcnt(4)
    v_mfma_f32_16x16x32_bf16 v[24:27], v[48:51], v[112:115], v[24:27]
    v_mfma_f32_16x16x32_bf16 v[24:27], v[52:55], v[116:119], v[24:27]
    v_mfma_f32_16x16x32_bf16 v[24:27], v[56:59], v[120:123], v[24:27]
    v_mfma_f32_16x16x32_bf16 v[24:27], v[60:63], v[28:31], v[24:27]
    ds_read_b128 v[112:115], v6 offset:768
    ds_read_b128 v[116:119], v6 offset:832
    ds_read_b128 v[120:123], v6 offset:896
    ds_read_b128 v[28:31], v6 offset:960
    s_waitcnt lgkmcnt(4)
    v_mfma_f32_16x16x32_bf16 v[24:27], v[64:67], v[8:11], v[24:27]
    v_mfma_f32_16x16x32_bf16 v[24:27], v[68:71], v[12:15], v[24:27]
    v_mfma_f32_16x16x32_bf16 v[24:27], v[72:75], v[16:19], v[24:27]
    v_mfma_f32_16x16x32_bf16 v[24:27], v[76:79], v[20:23], v[24:27]
    s_waitcnt lgkmcnt(0)
    v_mfma_f32_16x16x32_bf16 v[24:27], v[80:83], v[112:115], v[24:27]
    v_mfma_f32_16x16x32_bf16 v[24:27], v[84:87], v[116:119], v[24:27]
    v_mfma_f32_16x16x32_bf16 v[24:27], v[88:91], v[120:123], v[24:27]
    v_mfma_f32_16x16x32_bf16 v[24:27], v[92:95], v[28:31], v[24:27]
    s_nop 7
    v_cvt_pk_bf16_f32 v28, v24, v25
    v_mov_b32 v29, s4
    v_cvt_pk_bf16_f32 v30, v26, v27
    v_mov_b32 v31, s4
    s_and_b32 s66, s3, 3
    s_lshl_b32 s66, s66, 6
    s_add_u32 s65, s85, s66
    v_lshlrev_b32 v8, 12, v3
    v_lshl_add_u32 v8, v2, 4, v8
    v_cmp_gt_u32 vcc, 4, v3
    s_and_saveexec_b64 s[72:73], vcc
    buffer_store_dwordx4 v[28:31], v8, s[8:11], s65 offen sc1
    s_mov_b64 exec, s[72:73]
    v_mov_b32 v8, 160564
    v_mov_b32 v9, 1
    s_mov_b64 s[74:75], exec
    s_mov_b64 exec, 1
    ds_add_u32 v8, v9
    s_mov_b64 exec, s[74:75]
    s_branch Q4_77
Q8_76:
    s_load_dword s4, s[62:63], 0
    s_waitcnt lgkmcnt(0)
    s_add_u32 s4, s4, 0x9E3779B9
Q4_77:
    s_branch L_T_AUX
T2_75:
    s_load_dword s4, s[62:63], 0
    s_waitcnt lgkmcnt(0)
    s_add_u32 s4, s4, 0x9E3779B9
L_T_AUX:
    s_cmp_lt_u32 s3, 8
    s_cbranch_scc1 L_T_W
    s_cmp_lg_u32 s3, 9
    s_cbranch_scc1 W9_82
    v_lshlrev_b32 v5, 8, v1
    v_add_u32 v5, 1769472, v5
    s_mov_b64 s[98:99], exec
    s_mov_b32 exec_lo, 0xffff
    s_mov_b32 exec_hi, 0x0
    s_mov_b32 s82, 0
P_85:
    buffer_load_dwordx4 v[8:11], v5, s[8:11], 0 offen offset:0 sc1
    s_waitcnt vmcnt(0)
    v_cmp_eq_u32 vcc, s4, v9
    v_cmp_eq_u32 s[72:73], s4, v11
    s_and_b64 vcc, vcc, s[72:73]
    s_cmp_eq_u64 vcc, exec
    s_cbranch_scc1 PD_84
    s_sleep 4
    s_add_u32 s82, s82, 1
    s_cmp_lt_u32 s82, 200000
    s_cbranch_scc1 P_85
    s_branch L_END
PD_84:
    s_mov_b64 exec, s[98:99]
    v_mov_b32 v10, 160540
    v_mov_b32 v11, 1
    s_mov_b64 s[74:75], exec
    s_mov_b64 exec, 1
    ds_add_u32 v10, v11
    s_mov_b64 exec, s[74:75]
    s_branch L_T_MODS
W9_82:
    s_cmp_lg_u32 s3, 8
    s_cbranch_scc1 L_T_MODS
    s_getreg_b32 s64, hwreg(HW_REG_XCC_ID)
    s_and_b32 s64, s64, 0xf
    v_mov_b32 v8, s64
    v_mov_b32 v9, s4
    s_lshl_b32 s65, s6, 3
    s_add_u32 s65, s65, 256
    s_mov_b64 s[74:75], exec
    s_mov_b64 exec, 1
    buffer_store_dwordx2 v[8:9], off, s[8:11], s65 sc1
    s_mov_b64 exec, s[74:75]
    s_branch L_T_MODS
L_T_W:
    s_cmp_ge_u32 s6, 28
    s_cbranch_scc1 L_T_WEND
    s_mov_b32 s12, s48
    s_and_b32 s13, s49, 0xffff
    s_mov_b32 s14, 1835008
    s_mov_b32 s15, 0x20000
    s_mov_b32 s16, s50
    s_and_b32 s17, s51, 0xffff
    s_mov_b32 s18, 1835008
    s_mov_b32 s19, 0x20000
    s_mov_b32 s20, s52
    s_and_b32 s21, s53, 0xffff
    s_mov_b32 s22, 1835008
    s_mov_b32 s23, 0x20000
    v_mov_b32 v8, 160540
    s_mov_b32 s82, 0
W_86:
    ds_read_b32 v9, v8
    s_waitcnt lgkmcnt(0)
    v_readfirstlane_b32 s71, v9
    s_cmp_ge_u32 s71, 1
    s_cbranch_scc1 WD_87
    s_sleep 2
    s_add_u32 s82, s82, 1
    s_cmp_lt_u32 s82, 4000000
    s_cbranch_scc1 W_86
    s_branch L_END
WD_87:
    v_lshrrev_b32 v4, 3, v1
    v_mul_u32_u24 v4, 3584, v4
    v_bfe_u32 v5, v1, 1, 2
    v_bfe_u32 v6, v1, 4, 2
    v_xor_b32 v5, v5, v6
    v_lshl_add_u32 v4, v5, 5, v4
    v_and_b32 v5, 1, v1
    v_lshl_add_u32 v4, v5, 4, v4
    s_lshl_b32 s64, s3, 3
    s_mul_i32 s66, s64, 28672
    s_lshl_b32 s67, s6, 7
    s_add_u32 s66, s66, s67
    s_lshl_b32 s65, s3, 13
    s_add_u32 s65, s65, 65536
    s_mov_b32 m0, s65
    s_add_u32 s65, s65, 1024
    buffer_load_dwordx4 v4, s[16:19], s66 offen nt lds
    s_add_u32 s66, s66, 28672
    s_mov_b32 m0, s65
    s_add_u32 s65, s65, 1024
    buffer_load_dwordx4 v4, s[16:19], s66 offen nt lds
    s_add_u32 s66, s66, 28672
    s_mov_b32 m0, s65
    s_add_u32 s65, s65, 1024
    buffer_load_dwordx4 v4, s[16:19], s66 offen nt lds
    s_add_u32 s66, s66, 28672
    s_mov_b32 m0, s65
    s_add_u32 s65, s65, 1024
    buffer_load_dwordx4 v4, s[16:19], s66 offen nt lds
    s_add_u32 s66, s66, 28672
    s_mov_b32 m0, s65
    s_add_u32 s65, s65, 1024
    buffer_load_dwordx4 v4, s[16:19], s66 offen nt lds
    s_add_u32 s66, s66, 28672
    s_mov_b32 m0, s65
    s_add_u32 s65, s65, 1024
    buffer_load_dwordx4 v4, s[16:19], s66 offen nt lds
    s_add_u32 s66, s66, 28672
    s_mov_b32 m0, s65
    s_add_u32 s65, s65, 1024
    buffer_load_dwordx4 v4, s[16:19], s66 offen nt lds
    s_add_u32 s66, s66, 28672
    s_mov_b32 m0, s65
    s_add_u32 s65, s65, 1024
    buffer_load_dwordx4 v4, s[16:19], s66 offen nt lds
    s_add_u32 s66, s66, 28672
    s_cmp_ge_u32 s6, 16
    s_cbranch_scc1 NQD_88
    v_mov_b32 v8, 160564
    s_mov_b32 s82, 0
W_89:
    ds_read_b32 v9, v8
    s_waitcnt lgkmcnt(0)
    v_readfirstlane_b32 s71, v9
    s_cmp_ge_u32 s71, 4
    s_cbranch_scc1 WD_90
    s_sleep 1
    s_add_u32 s82, s82, 1
    s_cmp_lt_u32 s82, 4000000
    s_cbranch_scc1 W_89
    s_branch L_END
WD_90:
NQD_88:
    v_lshrrev_b32 v4, 3, v1
    v_mul_u32_u24 v4, 3584, v4
    v_bfe_u32 v5, v1, 1, 2
    v_bfe_u32 v6, v1, 4, 2
    v_xor_b32 v5, v5, v6
    v_lshl_add_u32 v4, v5, 5, v4
    v_and_b32 v5, 1, v1
    v_lshl_add_u32 v4, v5, 4, v4
    s_lshl_b32 s64, s3, 3
    s_mul_i32 s66, s64, 28672
    s_lshl_b32 s67, s6, 7
    s_add_u32 s66, s66, s67
    s_lshl_b32 s65, s3, 13
    s_add_u32 s65, s65, 0
    s_mov_b32 m0, s65
    s_add_u32 s65, s65, 1024
    buffer_load_dwordx4 v4, s[12:15], s66 offen nt lds
    s_add_u32 s66, s66, 28672
    s_mov_b32 m0, s65
    s_add_u32 s65, s65, 1024
    buffer_load_dwordx4 v4, s[12:15], s66 offen nt lds
    s_add_u32 s66, s66, 28672
    s_mov_b32 m0, s65
    s_add_u32 s65, s65, 1024
    buffer_load_dwordx4 v4, s[12:15], s66 offen nt lds
    s_add_u32 s66, s66, 28672
    s_mov_b32 m0, s65
    s_add_u32 s65, s65, 1024
    buffer_load_dwordx4 v4, s[12:15], s66 offen nt lds
    s_add_u32 s66, s66, 28672
    s_mov_b32 m0, s65
    s_add_u32 s65, s65, 1024
    buffer_load_dwordx4 v4, s[12:15], s66 offen nt lds
    s_add_u32 s66, s66, 28672
    s_mov_b32 m0, s65
    s_add_u32 s65, s65, 1024
    buffer_load_dwordx4 v4, s[12:15], s66 offen nt lds
    s_add_u32 s66, s66, 28672
    s_mov_b32 m0, s65
    s_add_u32 s65, s65, 1024
    buffer_load_dwordx4 v4, s[12:15], s66 offen nt lds
    s_add_u32 s66, s66, 28672
    s_mov_b32 m0, s65
    s_add_u32 s65, s65, 1024
    buffer_load_dwordx4 v4, s[12:15], s66 offen nt lds
    s_add_u32 s66, s66, 28672
    s_waitcnt vmcnt(8)
    v_mov_b32 v8, 160528
    v_mov_b32 v9, 1
    s_mov_b64 s[74:75], exec
    s_mov_b64 exec, 1
    ds_add_u32 v8, v9
    s_mov_b64 exec, s[74:75]
    s_cmp_lt_u32 s3, 4
    s_cbranch_scc1 NU_91
    v_mov_b32 v8, 160528
    s_mov_b32 s82, 0
W_92:
    ds_read_b32 v9, v8
    s_waitcnt lgkmcnt(0)
    v_readfirstlane_b32 s71, v9
    s_cmp_ge_u32 s71, 8
    s_cbranch_scc1 WD_93
    s_sleep 1
    s_add_u32 s82, s82, 1
    s_cmp_lt_u32 s82, 4000000
    s_cbranch_scc1 W_92
    s_branch L_END
WD_93:
    s_mov_b32 s64, 65536
    v_lshrrev_b32 v4, 2, v3
    v_lshl_add_u32 v4, v2, 2, v4
    v_bfe_u32 v5, v4, 1, 2
    s_and_b32 s65, s3, 3
    v_xor_b32 v5, s65, v5
    v_lshlrev_b32 v4, 7, v4
    v_lshl_add_u32 v4, v5, 5, v4
    v_and_b32 v5, 3, v1
    v_lshl_add_u32 v4, v5, 3, v4
    v_add_u32 v4, s64, v4
    ds_read_b64_tr_b16 v[32:33], v4 offset:0
    ds_read_b64_tr_b16 v[34:35], v4 offset:2048
    ds_read_b64_tr_b16 v[36:37], v4 offset:4096
    ds_read_b64_tr_b16 v[38:39], v4 offset:6144
    ds_read_b64_tr_b16 v[40:41], v4 offset:8192
    ds_read_b64_tr_b16 v[42:43], v4 offset:10240
    ds_read_b64_tr_b16 v[44:45], v4 offset:12288
    ds_read_b64_tr_b16 v[46:47], v4 offset:14336
    ds_read_b64_tr_b16 v[48:49], v4 offset:16384
    ds_read_b64_tr_b16 v[50:51], v4 offset:18432
    ds_read_b64_tr_b16 v[52:53], v4 offset:20480
    ds_read_b64_tr_b16 v[54:55], v4 offset:22528
    ds_read_b64_tr_b16 v[56:57], v4 offset:24576
    ds_read_b64_tr_b16 v[58:59], v4 offset:26624
    ds_read_b64_tr_b16 v[60:61], v4 offset:28672
    ds_read_b64_tr_b16 v[62:63], v4 offset:30720
    ds_read_b64_tr_b16 v[64:65], v4 offset:32768
    ds_read_b64_tr_b16 v[66:67], v4 offset:34816
    ds_read_b64_tr_b16 v[68:69], v4 offset:36864
    ds_read_b64_tr_b16 v[70:71], v4 offset:38912
    ds_read_b64_tr_b16 v[72:73], v4 offset:40960
    ds_read_b64_tr_b16 v[74:75], v4 offset:43008
    ds_read_b64_tr_b16 v[76:77], v4 offset:45056
    ds_read_b64_tr_b16 v[78:79], v4 offset:47104
    ds_read_b64_tr_b16 v[80:81], v4 offset:49152
    ds_read_b64_tr_b16 v[82:83], v4 offset:51200
    ds_read_b64_tr_b16 v[84:85], v4 offset:53248
    ds_read_b64_tr_b16 v[86:87], v4 offset:55296
    ds_read_b64_tr_b16 v[88:89], v4 offset:57344
    ds_read_b64_tr_b16 v[90:91], v4 offset:59392
    ds_read_b64_tr_b16 v[92:93], v4 offset:61440
    ds_read_b64_tr_b16 v[94:95], v4 offset:63488
    s_waitcnt lgkmcnt(0)
    v_mov_b32 v8, 160532
    v_mov_b32 v9, 1
    s_mov_b64 s[74:75], exec
    s_mov_b64 exec, 1
    ds_add_u32 v8, v9
    s_mov_b64 exec, s[74:75]
NU_91:
    v_mov_b32 v8, 160532
    s_mov_b32 s82, 0
W_94:
    ds_read_b32 v9, v8
    s_waitcnt lgkmcnt(0)
    v_readfirstlane_b32 s71, v9
    s_cmp_ge_u32 s71, 4
    s_cbranch_scc1 WD_95
    s_sleep 1
    s_add_u32 s82, s82, 1
    s_cmp_lt_u32 s82, 4000000
    s_cbranch_scc1 W_94
    s_branch L_END
WD_95:
    v_lshlrev_b32 v4, 4, v1
    s_lshl_b32 s64, s3, 13
    s_add_u32 s65, s64, 65536
    s_lshl_b32 s66, s6, 16
    s_add_u32 s66, s66, s64
    v_xor_b32 v5, 0, v4
    s_mov_b32 m0, s65
    s_add_u32 s65, s65, 1024
    buffer_load_dwordx4 v5, s[20:23], s66 offen nt lds
    s_add_u32 s66, s66, 1024
    v_xor_b32 v5, 32, v4
    s_mov_b32 m0, s65
    s_add_u32 s65, s65, 1024
    buffer_load_dwordx4 v5, s[20:23], s66 offen nt lds
    s_add_u32 s66, s66, 1024
    v_xor_b32 v5, 64, v4
    s_mov_b32 m0, s65
    s_add_u32 s65, s65, 1024
    buffer_load_dwordx4 v5, s[20:23], s66 offen nt lds
    s_add_u32 s66, s66, 1024
    v_xor_b32 v5, 96, v4
    s_mov_b32 m0, s65
    s_add_u32 s65, s65, 1024
    buffer_load_dwordx4 v5, s[20:23], s66 offen nt lds
    s_add_u32 s66, s66, 1024
    v_xor_b32 v5, 128, v4
    s_mov_b32 m0, s65
    s_add_u32 s65, s65, 1024
    buffer_load_dwordx4 v5, s[20:23], s66 offen nt lds
    s_add_u32 s66, s66, 1024
    v_xor_b32 v5, 160, v4
    s_mov_b32 m0, s65
    s_add_u32 s65, s65, 1024
    buffer_load_dwordx4 v5, s[20:23], s66 offen nt lds
    s_add_u32 s66, s66, 1024
    v_xor_b32 v5, 192, v4
    s_mov_b32 m0, s65
    s_add_u32 s65, s65, 1024
    buffer_load_dwordx4 v5, s[20:23], s66 offen nt lds
    s_add_u32 s66, s66, 1024
    v_xor_b32 v5, 224, v4
    s_mov_b32 m0, s65
    s_add_u32 s65, s65, 1024
    buffer_load_dwordx4 v5, s[20:23], s66 offen nt lds
    s_add_u32 s66, s66, 1024
    s_waitcnt vmcnt(8)
    v_mov_b32 v8, 160536
    v_mov_b32 v9, 1
    s_mov_b64 s[74:75], exec
    s_mov_b64 exec, 1
    ds_add_u32 v8, v9
    s_mov_b64 exec, s[74:75]
    s_cmp_ge_u32 s3, 4
    s_cbranch_scc1 NG_96
    v_mov_b32 v8, 160536
    s_mov_b32 s82, 0
W_97:
    ds_read_b32 v9, v8
    s_waitcnt lgkmcnt(0)
    v_readfirstlane_b32 s71, v9
    s_cmp_ge_u32 s71, 8
    s_cbranch_scc1 WD_98
    s_sleep 1
    s_add_u32 s82, s82, 1
    s_cmp_lt_u32 s82, 4000000
    s_cbranch_scc1 W_97
    s_branch L_END
WD_98:
    s_mov_b32 s64, 0
    v_lshrrev_b32 v4, 2, v3
    v_lshl_add_u32 v4, v2, 2, v4
    v_bfe_u32 v5, v4, 1, 2
    s_and_b32 s65, s3, 3
    v_xor_b32 v5, s65, v5
    v_lshlrev_b32 v4, 7, v4
    v_lshl_add_u32 v4, v5, 5, v4
    v_and_b32 v5, 3, v1
    v_lshl_add_u32 v4, v5, 3, v4
    v_add_u32 v4, s64, v4
    ds_read_b64_tr_b16 v[32:33], v4 offset:0
    ds_read_b64_tr_b16 v[34:35], v4 offset:2048
    ds_read_b64_tr_b16 v[36:37], v4 offset:4096
    ds_read_b64_tr_b16 v[38:39], v4 offset:6144
    ds_read_b64_tr_b16 v[40:41], v4 offset:8192
    ds_read_b64_tr_b16 v[42:43], v4 offset:10240
    ds_read_b64_tr_b16 v[44:45], v4 offset:12288
    ds_read_b64_tr_b16 v[46:47], v4 offset:14336
    ds_read_b64_tr_b16 v[48:49], v4 offset:16384
    ds_read_b64_tr_b16 v[50:51], v4 offset:18432
    ds_read_b64_tr_b16 v[52:53], v4 offset:20480
    ds_read_b64_tr_b16 v[54:55], v4 offset:22528
    ds_read_b64_tr_b16 v[56:57], v4 offset:24576
    ds_read_b64_tr_b16 v[58:59], v4 offset:26624
    ds_read_b64_tr_b16 v[60:61], v4 offset:28672
    ds_read_b64_tr_b16 v[62:63], v4 offset:30720
    ds_read_b64_tr_b16 v[64:65], v4 offset:32768
    ds_read_b64_tr_b16 v[66:67], v4 offset:34816
    ds_read_b64_tr_b16 v[68:69], v4 offset:36864
    ds_read_b64_tr_b16 v[70:71], v4 offset:38912
    ds_read_b64_tr_b16 v[72:73], v4 offset:40960
    ds_read_b64_tr_b16 v[74:75], v4 offset:43008
    ds_read_b64_tr_b16 v[76:77], v4 offset:45056
    ds_read_b64_tr_b16 v[78:79], v4 offset:47104
    ds_read_b64_tr_b16 v[80:81], v4 offset:49152
    ds_read_b64_tr_b16 v[82:83], v4 offset:51200
    ds_read_b64_tr_b16 v[84:85], v4 offset:53248
    ds_read_b64_tr_b16 v[86:87], v4 offset:55296
    ds_read_b64_tr_b16 v[88:89], v4 offset:57344
    ds_read_b64_tr_b16 v[90:91], v4 offset:59392
    ds_read_b64_tr_b16 v[92:93], v4 offset:61440
    ds_read_b64_tr_b16 v[94:95], v4 offset:63488
    s_waitcnt lgkmcnt(0)
NG_96:
    s_waitcnt vmcnt(0)
    v_mov_b32 v8, 160520
    v_mov_b32 v9, 1
    s_mov_b64 s[74:75], exec
    s_mov_b64 exec, 1
    ds_add_u32 v8, v9
    s_mov_b64 exec, s[74:75]
L_T_WEND:
    v_mov_b32 v8, 160556
    s_mov_b32 s82, 0
W_99:
    ds_read_b32 v9, v8
    s_waitcnt lgkmcnt(0)
    v_readfirstlane_b32 s71, v9
    s_cmp_ge_u32 s71, 1
    s_cbranch_scc1 WD_100
    s_sleep 2
    s_add_u32 s82, s82, 1
    s_cmp_lt_u32 s82, 4000000
    s_cbranch_scc1 W_99
    s_branch L_END
WD_100:
    v_mov_b32 v8, 160576
    ds_read_b32 v9, v8
    s_waitcnt lgkmcnt(0)
    v_readfirstlane_b32 s88, v9
    s_cmp_ge_u32 s6, 28
    s_cbranch_scc1 DF_101
    v_mov_b32 v8, 160520
    s_mov_b32 s82, 0
W_102:
    ds_read_b32 v9, v8
    s_waitcnt lgkmcnt(0)
    v_readfirstlane_b32 s71, v9
    s_cmp_ge_u32 s71, 8
    s_cbranch_scc1 WD_103
    s_sleep 1
    s_add_u32 s82, s82, 1
    s_cmp_lt_u32 s82, 4000000
    s_cbranch_scc1 W_102
    s_branch L_END
WD_103:
    v_lshrrev_b32 v10, 2, v3
    v_lshl_add_u32 v10, v2, 2, v10
    v_and_b32 v11, 7, v10
    s_lshl_b32 s64, s3, 1
    v_xor_b32 v11, s64, v11
    v_lshlrev_b32 v11, 5, v11
    v_lshl_add_u32 v11, v10, 10, v11
    v_and_b32 v10, 3, v1
    v_lshl_add_u32 v11, v10, 3, v11
    v_add_u32 v11, 0x10000, v11
    v_xor_b32 v10, 32, v11
    ds_read_b64_tr_b16 v[96:97], v11 offset:0
    ds_read_b64_tr_b16 v[98:99], v11 offset:16384
    ds_read_b64_tr_b16 v[100:101], v11 offset:32768
    ds_read_b64_tr_b16 v[102:103], v11 offset:49152
    ds_read_b64_tr_b16 v[104:105], v10 offset:0
    ds_read_b64_tr_b16 v[106:107], v10 offset:16384
    ds_read_b64_tr_b16 v[108:109], v10 offset:32768
    ds_read_b64_tr_b16 v[110:111], v10 offset:49152
    s_waitcnt lgkmcnt(0)
DF_101:
    s_lshl_b32 s70, s3, 10
    v_lshlrev_b32 v126, 4, v1
    v_add_u32 v126, s70, v126
    s_mul_i32 s64, s6, 7168
    s_add_u32 s64, s64, 1310720
    v_add_u32 v126, s64, v126
    s_lshl_b32 s64, s3, 8
    v_and_b32 v127, 31, v1
    v_lshlrev_b32 v127, 3, v127
    v_add_u32 v127, s64, v127
    v_add_u32 v127, 138752, v127
    s_branch L_T_H2
L_T_STREAM:
    s_sub_u32 s68, s3, 12
    s_lshl_b32 s64, s68, 10
    v_lshlrev_b32 v4, 4, v1
    buffer_load_dwordx4 v[8:11], v4, s[28:31], s64 offen
    s_barrier
    s_load_dword s4, s[62:63], 0
    s_waitcnt vmcnt(0)
    v_lshlrev_b32 v16, 16, v8
    v_and_b32 v17, 0xffff0000, v8
    v_lshlrev_b32 v18, 16, v9
    v_and_b32 v19, 0xffff0000, v9
    v_lshlrev_b32 v20, 16, v10
    v_and_b32 v21, 0xffff0000, v10
    v_lshlrev_b32 v22, 16, v11
    v_and_b32 v23, 0xffff0000, v11
    v_mul_f32 v24, 0xbfb8aa3b, v16
    v_exp_f32 v24, v24
    s_nop 0
    v_add_f32 v24, 1.0, v24
    v_rcp_f32 v25, v24
    s_nop 0
    v_mul_f32 v16, v16, v25
    v_mul_f32 v24, 0xbfb8aa3b, v17
    v_exp_f32 v24, v24
    s_nop 0
    v_add_f32 v24, 1.0, v24
    v_rcp_f32 v25, v24
    s_nop 0
    v_mul_f32 v17, v17, v25
    v_mul_f32 v24, 0xbfb8aa3b, v18
    v_exp_f32 v24, v24
    s_nop 0
    v_add_f32 v24, 1.0, v24
    v_rcp_f32 v25, v24
    s_nop 0
    v_mul_f32 v18, v18, v25
    v_mul_f32 v24, 0xbfb8aa3b, v19
    v_exp_f32 v24, v24
    s_nop 0
    v_add_f32 v24, 1.0, v24
    v_rcp_f32 v25, v24
    s_nop 0
    v_mul_f32 v19, v19, v25
    v_mul_f32 v24, 0xbfb8aa3b, v20
    v_exp_f32 v24, v24
    s_nop 0
    v_add_f32 v24, 1.0, v24
    v_rcp_f32 v25, v24
    s_nop 0
    v_mul_f32 v20, v20, v25
    v_mul_f32 v24, 0xbfb8aa3b, v21
    v_exp_f32 v24, v24
    s_nop 0
    v_add_f32 v24, 1.0, v24
    v_rcp_f32 v25, v24
    s_nop 0
    v_mul_f32 v21, v21, v25
    v_mul_f32 v24, 0xbfb8aa3b, v22
    v_exp_f32 v24, v24
    s_nop 0
    v_add_f32 v24, 1.0, v24
    v_rcp_f32 v25, v24
    s_nop 0
    v_mul_f32 v22, v22, v25
    v_mul_f32 v24, 0xbfb8aa3b, v23
    v_exp_f32 v24, v24
    s_nop 0
    v_add_f32 v24, 1.0, v24
    v_rcp_f32 v25, v24
    s_nop 0
    v_mul_f32 v23, v23, v25
    v_cvt_pk_bf16_f32 v8, v16, v17
    v_cvt_pk_bf16_f32 v9, v18, v19
    v_cvt_pk_bf16_f32 v10, v20, v21
    v_cvt_pk_bf16_f32 v11, v22, v23
    v_lshrrev_b32 v6, 2, v1
    v_lshlrev_b32 v6, 6, v6
    v_and_b32 v7, 1, v1
    v_lshl_add_u32 v6, v7, 5, v6
    v_bfe_u32 v7, v1, 1, 1
    v_lshl_add_u32 v6, v7, 3, v6
    s_mul_i32 s64, s68, 1088
    s_add_u32 s64, s64, 155648
    v_add_u32 v6, s64, v6
    ds_write_b64 v6, v[8:9]
    ds_write_b64 v6, v[10:11] offset:16
    v_mov_b32 v24, 160516
    v_mov_b32 v25, 1
    s_mov_b64 s[74:75], exec
    s_mov_b64 exec, 1
    ds_add_u32 v24, v25
    s_mov_b64 exec, s[74:75]
    s_waitcnt lgkmcnt(0)
    s_add_u32 s4, s4, 0x9E3779B9
L_T_MODS:
    v_mov_b32 v4, 160540
    s_mov_b32 s82, 0
W_105:
    ds_read_b32 v5, v4
    s_waitcnt lgkmcnt(0)
    v_readfirstlane_b32 s71, v5
    s_cmp_ge_u32 s71, 1
    s_cbranch_scc1 WD_106
    s_sleep 4
    s_add_u32 s82, s82, 1
    s_cmp_lt_u32 s82, 4000000
    s_cbranch_scc1 W_105
    s_branch L_END
WD_106:
    s_cmp_ge_u32 s3, 12
    s_cbranch_scc1 LM_107
    s_sub_u32 s64, s3, 8
    s_lshl_b32 s64, s64, 13
    s_add_u32 s64, s64, 32768
    v_lshlrev_b32 v4, 4, v1
    v_add_u32 v4, s64, v4
    v_add_u32 v5, 2048, v4
    v_add_u32 v6, 4096, v4
    s_mov_b32 s82, 0
P_110:
    buffer_load_dwordx4 v[32:35], v5, s[8:11], 0 offen offset:0 sc1
    buffer_load_dwordx4 v[36:39], v5, s[8:11], 0 offen offset:1024 sc1
    buffer_load_dwordx4 v[40:43], v6, s[8:11], 0 offen offset:0 sc1
    buffer_load_dwordx4 v[44:47], v6, s[8:11], 0 offen offset:1024 sc1
    s_waitcnt vmcnt(0)
    v_cmp_eq_u32 vcc, s4, v33
    v_cmp_eq_u32 s[72:73], s4, v35
    s_and_b64 vcc, vcc, s[72:73]
    v_cmp_eq_u32 s[72:73], s4, v37
    s_and_b64 vcc, vcc, s[72:73]
    v_cmp_eq_u32 s[72:73], s4, v39
    s_and_b64 vcc, vcc, s[72:73]
    v_cmp_eq_u32 s[72:73], s4, v41
    s_and_b64 vcc, vcc, s[72:73]
    v_cmp_eq_u32 s[72:73], s4, v43
    s_and_b64 vcc, vcc, s[72:73]
    v_cmp_eq_u32 s[72:73], s4, v45
    s_and_b64 vcc, vcc, s[72:73]
    v_cmp_eq_u32 s[72:73], s4, v47
    s_and_b64 vcc, vcc, s[72:73]
    s_cmp_eq_u64 vcc, exec
    s_cbranch_scc1 PD_109
    s_sleep 2
    s_add_u32 s82, s82, 1
    s_cmp_lt_u32 s82, 200000
    s_cbranch_scc1 P_110
    s_branch L_END
PD_109:
    v_lshlrev_b32 v48, 16, v32
    v_and_b32 v49, 0xffff0000, v32
    v_lshlrev_b32 v50, 16, v34
    v_and_b32 v51, 0xffff0000, v34
    v_lshlrev_b32 v52, 16, v36
    v_and_b32 v53, 0xffff0000, v36
    v_lshlrev_b32 v54, 16, v38
    v_and_b32 v55, 0xffff0000, v38
    v_lshlrev_b32 v56, 16, v40
    v_and_b32 v57, 0xffff0000, v40
    v_lshlrev_b32 v58, 16, v42
    v_and_b32 v59, 0xffff0000, v42
    v_lshlrev_b32 v60, 16, v44
    v_and_b32 v61, 0xffff0000, v44
    v_lshlrev_b32 v62, 16, v46
    v_and_b32 v63, 0xffff0000, v46
    v_add_f32 v56, 1.0, v56
    v_add_f32 v57, 1.0, v57
    v_add_f32 v58, 1.0, v58
    v_add_f32 v59, 1.0, v59
    v_add_f32 v60, 1.0, v60
    v_add_f32 v61, 1.0, v61
    v_add_f32 v62, 1.0, v62
    v_add_f32 v63, 1.0, v63
    v_cvt_pk_bf16_f32 v4, v56, v57
    v_lshlrev_b32 v56, 16, v4
    v_and_b32 v57, 0xffff0000, v4
    v_cvt_pk_bf16_f32 v4, v58, v59
    v_lshlrev_b32 v58, 16, v4
    v_and_b32 v59, 0xffff0000, v4
    v_cvt_pk_bf16_f32 v4, v60, v61
    v_lshlrev_b32 v60, 16, v4
    v_and_b32 v61, 0xffff0000, v4
    v_cvt_pk_bf16_f32 v4, v62, v63
    v_lshlrev_b32 v62, 16, v4
    v_and_b32 v63, 0xffff0000, v4
    s_branch B2_104
LM_107:
    s_cmp_lg_u32 s3, 12
    s_cbranch_scc1 LM_108
    v_lshrrev_b32 v4, 2, v1
    v_lshlrev_b32 v4, 13, v4
    v_and_b32 v5, 3, v1
    v_lshl_add_u32 v4, v5, 4, v4
    s_lshl_b32 s64, s6, 6
    s_add_u32 s64, s64, 32768
    v_add_u32 v4, s64, v4
    v_add_u32 v6, 6144, v4
    v_lshrrev_b32 v7, 2, v1
    v_lshlrev_b32 v7, 10, v7
    v_lshl_add_u32 v7, v5, 3, v7
    s_lshl_b32 s64, s6, 5
    s_mov_b64 s[98:99], exec
    s_mov_b64 exec, 0xffff
    buffer_load_dwordx2 v[44:45], v7, s[32:35], s64 offen
    s_mov_b32 s82, 0
P_112:
    buffer_load_dwordx4 v[32:35], v4, s[8:11], 0 offen offset:0 sc1
    buffer_load_dwordx4 v[36:39], v6, s[8:11], 0 offen offset:0 sc1
    s_waitcnt vmcnt(0)
    v_cmp_eq_u32 vcc, s4, v33
    v_cmp_eq_u32 s[72:73], s4, v35
    s_and_b64 vcc, vcc, s[72:73]
    v_cmp_eq_u32 s[72:73], s4, v37
    s_and_b64 vcc, vcc, s[72:73]
    v_cmp_eq_u32 s[72:73], s4, v39
    s_and_b64 vcc, vcc, s[72:73]
    s_cmp_eq_u64 vcc, exec
    s_cbranch_scc1 PD_111
    s_sleep 2
    s_add_u32 s82, s82, 1
    s_cmp_lt_u32 s82, 200000
    s_cbranch_scc1 P_112
    s_branch L_END
PD_111:
    s_mov_b64 exec, s[98:99]
    v_lshlrev_b32 v48, 16, v32
    v_and_b32 v49, 0xffff0000, v32
    v_lshlrev_b32 v50, 16, v34
    v_and_b32 v51, 0xffff0000, v34
    v_lshlrev_b32 v52, 16, v36
    v_and_b32 v53, 0xffff0000, v36
    v_lshlrev_b32 v54, 16, v38
    v_and_b32 v55, 0xffff0000, v38
    v_lshlrev_b32 v56, 16, v44
    v_and_b32 v57, 0xffff0000, v44
    v_lshlrev_b32 v58, 16, v45
    v_and_b32 v59, 0xffff0000, v45
    s_branch B2_104
LM_108:
    s_cmp_lg_u32 s3, 13
    s_cbranch_scc1 B2_104
    v_lshlrev_b32 v5, 4, v1
    v_add_u32 v5, 256, v5
    s_mov_b64 s[98:99], exec
    s_mov_b64 exec, 0xffff
    s_mov_b32 s82, 0
P_114:
    buffer_load_dwordx4 v[8:11], v5, s[8:11], 0 offen offset:0 sc1
    s_waitcnt vmcnt(0)
    v_cmp_eq_u32 vcc, s4, v9
    v_cmp_eq_u32 s[72:73], s4, v11
    s_and_b64 vcc, vcc, s[72:73]
    s_cmp_eq_u64 vcc, exec
    s_cbranch_scc1 PD_113
    s_sleep 4
    s_add_u32 s82, s82, 1
    s_cmp_lt_u32 s82, 200000
    s_cbranch_scc1 P_114
    s_branch L_END
PD_113:
    s_getreg_b32 s64, hwreg(HW_REG_XCC_ID)
    s_and_b32 s64, s64, 0xf
    v_cmp_eq_u32 vcc, s64, v8
    v_cmp_eq_u32 s[72:73], s64, v10
    s_and_b64 vcc, vcc, s[72:73]
    s_cmp_eq_u64 vcc, exec
    s_cselect_b32 s88, 1, 0
    s_mov_b64 exec, s[98:99]
    v_mov_b32 v8, 160576
    v_mov_b32 v9, s88
    ds_write_b32 v8, v9
    v_mov_b32 v10, 160556
    v_mov_b32 v11, 1
    s_mov_b64 s[74:75], exec
    s_mov_b64 exec, 1
    ds_add_u32 v10, v11
    s_mov_b64 exec, s[74:75]
B2_104:
    v_mov_b32 v8, 160556
    s_mov_b32 s82, 0
W_115:
    ds_read_b32 v9, v8
    s_waitcnt lgkmcnt(0)
    v_readfirstlane_b32 s71, v9
    s_cmp_ge_u32 s71, 1
    s_cbranch_scc1 WD_116
    s_sleep 2
    s_add_u32 s82, s82, 1
    s_cmp_lt_u32 s82, 4000000
    s_cbranch_scc1 W_115
    s_branch L_END
WD_116:
    v_mov_b32 v8, 160576
    ds_read_b32 v9, v8
    s_waitcnt lgkmcnt(0)
    v_readfirstlane_b32 s88, v9
    s_lshl_b32 s70, s3, 10
    v_lshlrev_b32 v126, 4, v1
    v_add_u32 v126, s70, v126
    s_mul_i32 s64, s6, 7168
    s_add_u32 s64, s64, 1310720
    v_add_u32 v126, s64, v126
    s_lshl_b32 s64, s3, 8
    v_and_b32 v127, 31, v1
    v_lshlrev_b32 v127, 3, v127
    v_add_u32 v127, s64, v127
    v_add_u32 v127, 138752, v127
    s_sub_u32 s68, s3, 8
    s_lshl_b32 s70, s68, 10
    v_lshlrev_b32 v124, 4, v1
    v_add_u32 v124, s70, v124
    s_lshl_b32 s64, s6, 13
    s_add_u32 s64, s64, 786432
    v_add_u32 v124, s64, v124
    s_lshl_b32 s64, s68, 8
    v_lshlrev_b32 v125, 4, v3
    v_add_u32 v125, s64, v125
    v_add_u32 v125, 138752, v125
    s_cmp_eq_u32 s88, 1
    s_cbranch_scc0 PW_117
    s_lshl_b32 s70, s68, 10
    v_lshlrev_b32 v4, 4, v1
    v_add_u32 v4, s70, v4
    s_mul_i32 s64, s6, 7168
    s_add_u32 s64, s64, 1310720
    buffer_load_dwordx4 v[8:11], v4, s[8:11], s64 offen nt
    s_lshl_b32 s64, s6, 8
    s_add_u32 s64, s64, 12288
    v_lshlrev_b32 v4, 4, v1
    s_mov_b64 exec, 0xffff
    buffer_load_dwordx4 v[16:19], v4, s[8:11], s64 offen nt
    s_mov_b64 exec, -1
    s_waitcnt vmcnt(0)
PW_117:
    s_cmp_lg_u32 s3, 8
    s_cbranch_scc1 ARM_118
    s_mul_i32 s64, s6, 448
    s_add_u32 s64, s64, 131072
    v_lshlrev_b32 v4, 4, v1
    v_add_u32 v4, s64, v4
    s_mov_b32 s69, 0
    s_mov_b32 s82, 0
    s_mov_b32 exec_lo, 0x0fffffff
    s_mov_b32 exec_hi, 0
AL_119:
    buffer_load_dwordx4 v[8:11], v4, s[8:11], 0 offen sc1
    s_waitcnt vmcnt(0)
    v_cmp_eq_u32 vcc, s4, v9
    v_cmp_eq_u32 s[72:73], s4, v11
    s_and_b64 vcc, vcc, s[72:73]
    s_cmp_eq_u64 vcc, 0
    s_cbranch_scc1 GO_120
    s_cmp_lg_u32 s69, 0
    s_cbranch_scc1 GO_120
    s_mov_b32 s69, 1
    s_mov_b64 s[96:97], vcc
    v_mov_b32 v12, 160544
    v_mov_b32 v13, 1
    s_mov_b64 s[74:75], exec
    s_mov_b64 exec, 1
    ds_add_u32 v12, v13
    s_mov_b64 exec, s[74:75]
    s_mov_b64 vcc, s[96:97]
GO_120:
    s_cmp_eq_u64 vcc, exec
    s_cbranch_scc1 AD_121
    s_sleep 3
    s_add_u32 s82, s82, 1
    s_cmp_lt_u32 s82, 200000
    s_cbranch_scc1 AL_119
    s_branch L_END
AD_121:
    s_mov_b64 exec, -1
    v_mov_b32 v12, 160548
    v_mov_b32 v13, 1
    s_mov_b64 s[74:75], exec
    s_mov_b64 exec, 1
    ds_add_u32 v12, v13
    s_mov_b64 exec, s[74:75]
ARM_118:
    v_mov_b32 v8, 160548
    s_mov_b32 s82, 0
W_122:
    ds_read_b32 v9, v8
    s_waitcnt lgkmcnt(0)
    v_readfirstlane_b32 s71, v9
    s_cmp_ge_u32 s71, 1
    s_cbranch_scc1 WD_123
    s_sleep 1
    s_add_u32 s82, s82, 1
    s_cmp_lt_u32 s82, 4000000
    s_cbranch_scc1 W_122
    s_branch L_END
WD_123:
    s_mov_b32 s82, 0
P_125:
    buffer_load_dwordx4 v[8:11], v124, s[8:11], 0 offen offset:0 sc1
    s_waitcnt vmcnt(0)
    v_cmp_eq_u32 vcc, s4, v9
    v_cmp_eq_u32 s[72:73], s4, v11
    s_and_b64 vcc, vcc, s[72:73]
    s_cmp_eq_u64 vcc, exec
    s_cbranch_scc1 PD_124
    s_add_u32 s82, s82, 1
    s_cmp_lt_u32 s82, 200000
    s_cbranch_scc1 P_125
    s_branch L_END
PD_124:
    v_lshlrev_b32 v12, 16, v8
    v_and_b32 v13, 0xffff0000, v8
    v_lshlrev_b32 v14, 16, v10
    v_and_b32 v15, 0xffff0000, v10
    v_mov_b32 v16, v12
    v_mov_b32 v17, v13
    v_mov_b32 v18, v14
    v_mov_b32 v19, v15
    s_nop 0
    v_permlane16_swap_b32 v12, v16
    v_permlane16_swap_b32 v13, v17
    v_permlane16_swap_b32 v14, v18
    v_permlane16_swap_b32 v15, v19
    s_nop 0
    v_pk_add_f32 v[12:13], v[12:13], v[16:17]
    v_pk_add_f32 v[14:15], v[14:15], v[18:19]
    v_mov_b32 v16, v12
    v_mov_b32 v17, v13
    v_mov_b32 v18, v14
    v_mov_b32 v19, v15
    s_nop 0
    v_permlane32_swap_b32 v12, v16
    v_permlane32_swap_b32 v13, v17
    v_permlane32_swap_b32 v14, v18
    v_permlane32_swap_b32 v15, v19
    s_nop 0
    v_pk_add_f32 v[12:13], v[12:13], v[16:17]
    v_pk_add_f32 v[14:15], v[14:15], v[18:19]
    s_mov_b64 exec, 0xffff
    ds_write_b128 v125, v[12:15]
    s_mov_b64 exec, -1
    v_mov_b32 v12, 160552
    v_mov_b32 v13, 1
    s_mov_b64 s[74:75], exec
    s_mov_b64 exec, 1
    ds_add_u32 v12, v13
    s_mov_b64 exec, s[74:75]
    s_cmp_eq_u32 s3, 12
    s_cbranch_scc1 W12B_127
    s_cmp_ge_u32 s6, 28
    s_cbranch_scc1 DF_128
    v_mov_b32 v8, 160520
    s_mov_b32 s82, 0
W_129:
    ds_read_b32 v9, v8
    s_waitcnt lgkmcnt(0)
    v_readfirstlane_b32 s71, v9
    s_cmp_ge_u32 s71, 8
    s_cbranch_scc1 WD_130
    s_sleep 1
    s_add_u32 s82, s82, 1
    s_cmp_lt_u32 s82, 4000000
    s_cbranch_scc1 W_129
    s_branch L_END
WD_130:
    v_lshrrev_b32 v10, 2, v3
    v_lshl_add_u32 v10, v2, 2, v10
    v_and_b32 v11, 7, v10
    s_lshl_b32 s64, s3, 1
    v_xor_b32 v11, s64, v11
    v_lshlrev_b32 v11, 5, v11
    v_lshl_add_u32 v11, v10, 10, v11
    v_and_b32 v10, 3, v1
    v_lshl_add_u32 v11, v10, 3, v11
    v_add_u32 v11, 0x10000, v11
    v_xor_b32 v10, 32, v11
    ds_read_b64_tr_b16 v[96:97], v11 offset:0
    ds_read_b64_tr_b16 v[98:99], v11 offset:16384
    ds_read_b64_tr_b16 v[100:101], v11 offset:32768
    ds_read_b64_tr_b16 v[102:103], v11 offset:49152
    ds_read_b64_tr_b16 v[104:105], v10 offset:0
    ds_read_b64_tr_b16 v[106:107], v10 offset:16384
    ds_read_b64_tr_b16 v[108:109], v10 offset:32768
    ds_read_b64_tr_b16 v[110:111], v10 offset:49152
    s_waitcnt lgkmcnt(0)
DF_128:
    s_branch W12_126
W12B_127:
    v_mov_b32 v8, 160552
    s_mov_b32 s82, 0
W_131:
    ds_read_b32 v9, v8
    s_waitcnt lgkmcnt(0)
    v_readfirstlane_b32 s71, v9
    s_cmp_ge_u32 s71, 8
    s_cbranch_scc1 WD_132
    s_add_u32 s82, s82, 1
    s_cmp_lt_u32 s82, 4000000
    s_cbranch_scc1 W_131
    s_branch L_END
WD_132:
    v_lshlrev_b32 v4, 9, v2
    v_lshl_add_u32 v4, v3, 4, v4
    v_add_u32 v4, 138752, v4
    ds_read_b128 v[8:11], v4 offset:0
    ds_read_b128 v[12:15], v4 offset:256
    v_lshrrev_b32 v4, 2, v1
    v_lshlrev_b32 v4, 11, v4
    v_and_b32 v5, 3, v1
    v_lshl_add_u32 v4, v5, 4, v4
    s_lshl_b32 s64, s6, 6
    s_add_u32 s64, s64, 12288
    s_waitcnt lgkmcnt(0)
    v_pk_add_f32 v[8:9], v[8:9], v[12:13]
    v_pk_add_f32 v[10:11], v[10:11], v[14:15]
    v_mov_b32 v12, v8
    v_mov_b32 v13, v9
    v_mov_b32 v14, v10
    v_mov_b32 v15, v11
    s_nop 0
    v_permlane16_swap_b32 v8, v12
    v_permlane16_swap_b32 v9, v13
    v_permlane16_swap_b32 v10, v14
    v_permlane16_swap_b32 v11, v15
    s_nop 0
    v_pk_add_f32 v[8:9], v[8:9], v[12:13]
    v_pk_add_f32 v[10:11], v[10:11], v[14:15]
    v_mov_b32 v12, v8
    v_mov_b32 v13, v9
    v_mov_b32 v14, v10
    v_mov_b32 v15, v11
    s_nop 0
    v_permlane32_swap_b32 v8, v12
    v_permlane32_swap_b32 v9, v13
    v_permlane32_swap_b32 v10, v14
    v_permlane32_swap_b32 v11, v15
    s_nop 0
    v_pk_add_f32 v[8:9], v[8:9], v[12:13]
    v_pk_add_f32 v[10:11], v[10:11], v[14:15]
    v_mov_b32 v17, s4
    v_mov_b32 v19, s4
    v_cvt_pk_bf16_f32 v12, v8, v9
    v_lshlrev_b32 v8, 16, v12
    v_and_b32 v9, 0xffff0000, v12
    v_cvt_pk_bf16_f32 v13, v10, v11
    v_lshlrev_b32 v10, 16, v13
    v_and_b32 v11, 0xffff0000, v13
    v_pk_mul_f32 v[8:9], v[48:49], v[8:9]
    v_pk_mul_f32 v[10:11], v[50:51], v[10:11]
    v_cvt_pk_bf16_f32 v12, v8, v9
    v_lshlrev_b32 v8, 16, v12
    v_and_b32 v9, 0xffff0000, v12
    v_cvt_pk_bf16_f32 v13, v10, v11
    v_lshlrev_b32 v10, 16, v13
    v_and_b32 v11, 0xffff0000, v13
    v_pk_add_f32 v[8:9], v[56:57], v[8:9]
    v_pk_add_f32 v[10:11], v[58:59], v[10:11]
    v_cvt_pk_bf16_f32 v16, v8, v9
    v_cvt_pk_bf16_f32 v18, v10, v11
    s_mov_b64 exec, 0xffff
    s_cmp_eq_u32 s88, 1
    s_cbranch_scc0 SC_133
    buffer_store_dwordx4 v[16:19], v4, s[8:11], s64 offen
    s_branch SD_134
SC_133:
    buffer_store_dwordx4 v[16:19], v4, s[8:11], s64 offen sc1
SD_134:
    s_mov_b64 exec, -1
    v_lshlrev_b32 v60, 16, v16
    v_and_b32 v61, 0xffff0000, v16
    v_lshlrev_b32 v62, 16, v18
    v_and_b32 v63, 0xffff0000, v18
    s_cmp_ge_u32 s6, 28
    s_cbranch_scc1 DF_135
    v_mov_b32 v8, 160520
    s_mov_b32 s82, 0
W_136:
    ds_read_b32 v9, v8
    s_waitcnt lgkmcnt(0)
    v_readfirstlane_b32 s71, v9
    s_cmp_ge_u32 s71, 8
    s_cbranch_scc1 WD_137
    s_sleep 1
    s_add_u32 s82, s82, 1
    s_cmp_lt_u32 s82, 4000000
    s_cbranch_scc1 W_136
    s_branch L_END
WD_137:
    v_lshrrev_b32 v10, 2, v3
    v_lshl_add_u32 v10, v2, 2, v10
    v_and_b32 v11, 7, v10
    s_lshl_b32 s64, s3, 1
    v_xor_b32 v11, s64, v11
    v_lshlrev_b32 v11, 5, v11
    v_lshl_add_u32 v11, v10, 10, v11
    v_and_b32 v10, 3, v1
    v_lshl_add_u32 v11, v10, 3, v11
    v_add_u32 v11, 0x10000, v11
    v_xor_b32 v10, 32, v11
    ds_read_b64_tr_b16 v[96:97], v11 offset:0
    ds_read_b64_tr_b16 v[98:99], v11 offset:16384
    ds_read_b64_tr_b16 v[100:101], v11 offset:32768
    ds_read_b64_tr_b16 v[102:103], v11 offset:49152
    ds_read_b64_tr_b16 v[104:105], v10 offset:0
    ds_read_b64_tr_b16 v[106:107], v10 offset:16384
    ds_read_b64_tr_b16 v[108:109], v10 offset:32768
    ds_read_b64_tr_b16 v[110:111], v10 offset:49152
    s_waitcnt lgkmcnt(0)
DF_135:
W12_126:
    s_cmp_lt_u32 s3, 8
    s_cbranch_scc1 LN_138
    s_cmp_ge_u32 s3, 12
    s_cbranch_scc1 LN_138
    s_sub_u32 s68, s3, 8
    s_lshl_b32 s64, s68, 11
    s_add_u32 s64, s64, 12288
    v_lshlrev_b32 v4, 4, v1
    v_add_u32 v4, s64, v4
    v_lshrrev_b32 v6, 3, v1
    v_lshlrev_b32 v6, 6, v6
    v_and_b32 v7, 3, v1
    v_lshl_add_u32 v6, v7, 4, v6
    v_bfe_u32 v7, v1, 2, 1
    v_lshl_add_u32 v6, v7, 3, v6
    s_mul_i32 s64, s68, 1088
    s_add_u32 s64, s64, 131584
    v_add_u32 v6, s64, v6
    s_mov_b32 s82, 0
    s_cmp_eq_u32 s88, 1
    s_cbranch_scc0 PS_140
P_141:
    buffer_load_dwordx4 v[8:11], v4, s[8:11], 0 offen offset:0 nt
    buffer_load_dwordx4 v[12:15], v4, s[8:11], 0 offen offset:1024 nt
    s_waitcnt vmcnt(0)
    v_cmp_eq_u32 vcc, s4, v9
    v_cmp_eq_u32 s[72:73], s4, v11
    s_and_b64 vcc, vcc, s[72:73]
    v_cmp_eq_u32 s[72:73], s4, v13
    s_and_b64 vcc, vcc, s[72:73]
    v_cmp_eq_u32 s[72:73], s4, v15
    s_and_b64 vcc, vcc, s[72:73]
    s_cmp_eq_u64 vcc, exec
    s_cbranch_scc1 PD_139
    s_add_u32 s82, s82, 1
    s_cmp_lt_u32 s82, 200000
    s_cbranch_scc1 P_141
    s_branch L_END
PS_140:
P_142:
    buffer_load_dwordx4 v[8:11], v4, s[8:11], 0 offen offset:0 sc1
    buffer_load_dwordx4 v[12:15], v4, s[8:11], 0 offen offset:1024 sc1
    s_waitcnt vmcnt(0)
    v_cmp_eq_u32 vcc, s4, v9
    v_cmp_eq_u32 s[72:73], s4, v11
    s_and_b64 vcc, vcc, s[72:73]
    v_cmp_eq_u32 s[72:73], s4, v13
    s_and_b64 vcc, vcc, s[72:73]
    v_cmp_eq_u32 s[72:73], s4, v15
    s_and_b64 vcc, vcc, s[72:73]
    s_cmp_eq_u64 vcc, exec
    s_cbranch_scc1 PD_139
    s_add_u32 s82, s82, 1
    s_cmp_lt_u32 s82, 200000
    s_cbranch_scc1 P_142
    s_branch L_END
PD_139:
    v_lshlrev_b32 v16, 16, v8
    v_and_b32 v17, 0xffff0000, v8
    v_lshlrev_b32 v18, 16, v10
    v_and_b32 v19, 0xffff0000, v10
    v_lshlrev_b32 v20, 16, v12
    v_and_b32 v21, 0xffff0000, v12
    v_lshlrev_b32 v22, 16, v14
    v_and_b32 v23, 0xffff0000, v14
    v_readfirstlane_b32 s64, v16
    v_readfirstlane_b32 s65, v16
    s_nop 1
    v_pk_add_f32 v[28:29], v[16:17], s[64:65] neg_lo:[0,1] neg_hi:[0,1]
    v_pk_add_f32 v[30:31], v[18:19], s[64:65] neg_lo:[0,1] neg_hi:[0,1]
    v_pk_add_f32 v[32:33], v[20:21], s[64:65] neg_lo:[0,1] neg_hi:[0,1]
    v_pk_add_f32 v[34:35], v[22:23], s[64:65] neg_lo:[0,1] neg_hi:[0,1]
    v_pk_add_f32 v[26:27], v[28:29], v[30:31]
    v_pk_mul_f32 v[24:25], v[28:29], v[28:29]
    v_pk_add_f32 v[26:27], v[26:27], v[32:33]
    v_pk_fma_f32 v[24:25], v[30:31], v[30:31], v[24:25]
    v_pk_add_f32 v[26:27], v[26:27], v[34:35]
    v_pk_fma_f32 v[24:25], v[32:33], v[32:33], v[24:25]
    v_pk_fma_f32 v[24:25], v[34:35], v[34:35], v[24:25]
    v_add_f32 v25, v24, v25
    v_add_f32 v24, v26, v27
    s_nop 1
    v_add_f32_dpp v24, v24, v24 quad_perm:[1,0,3,2] row_mask:0xf bank_mask:0xf
    v_add_f32_dpp v25, v25, v25 quad_perm:[1,0,3,2] row_mask:0xf bank_mask:0xf
    s_nop 0
    v_add_f32_dpp v24, v24, v24 quad_perm:[2,3,0,1] row_mask:0xf bank_mask:0xf
    v_add_f32_dpp v25, v25, v25 quad_perm:[2,3,0,1] row_mask:0xf bank_mask:0xf
    s_nop 0
    v_add_f32_dpp v24, v24, v24 row_half_mirror row_mask:0xf bank_mask:0xf
    v_add_f32_dpp v25, v25, v25 row_half_mirror row_mask:0xf bank_mask:0xf
    s_nop 0
    v_add_f32_dpp v24, v24, v24 row_mirror row_mask:0xf bank_mask:0xf
    v_add_f32_dpp v25, v25, v25 row_mirror row_mask:0xf bank_mask:0xf
    s_nop 0
    v_mov_b32 v26, v24
    v_mov_b32 v27, v25
    s_nop 1
    v_permlane16_swap_b32 v24, v26
    v_permlane16_swap_b32 v25, v27
    s_nop 0
    v_add_f32 v24, v24, v26
    v_add_f32 v25, v25, v27
    v_mov_b32 v26, v24
    v_mov_b32 v27, v25
    s_nop 1
    v_permlane32_swap_b32 v24, v26
    v_permlane32_swap_b32 v25, v27
    s_nop 0
    v_add_f32 v24, v24, v26
    v_add_f32 v25, v25, v27
    v_mul_f32 v24, 0x3b000000, v24
    v_mul_f32 v25, 0x3b000000, v25
    v_fma_f32 v25, -v24, v24, v25
    v_add_f32 v24, s64, v24
    v_max_f32 v25, 0, v25
    v_cvt_pk_bf16_f32 v26, v24, v25
    v_lshlrev_b32 v24, 16, v26
    v_and_b32 v25, 0xffff0000, v26
    v_add_f32 v25, 0x3727c5ac, v25
    v_cvt_pk_bf16_f32 v26, v25, v25
    v_lshlrev_b32 v25, 16, v26
    v_sqrt_f32 v25, v25
    s_nop 0
    v_pk_add_f32 v[16:17], v[16:17], v[24:25] op_sel_hi:[1,0] neg_lo:[0,1] neg_hi:[0,1]
    v_pk_add_f32 v[18:19], v[18:19], v[24:25] op_sel_hi:[1,0] neg_lo:[0,1] neg_hi:[0,1]
    v_pk_add_f32 v[20:21], v[20:21], v[24:25] op_sel_hi:[1,0] neg_lo:[0,1] neg_hi:[0,1]
    v_pk_add_f32 v[22:23], v[22:23], v[24:25] op_sel_hi:[1,0] neg_lo:[0,1] neg_hi:[0,1]
    v_cvt_pk_bf16_f32 v26, v25, v25
    v_lshlrev_b32 v25, 16, v26
    v_rcp_f32 v26, v25
    v_cvt_pk_bf16_f32 v28, v16, v17
    v_lshlrev_b32 v16, 16, v28
    v_and_b32 v17, 0xffff0000, v28
    v_cvt_pk_bf16_f32 v28, v18, v19
    v_lshlrev_b32 v18, 16, v28
    v_and_b32 v19, 0xffff0000, v28
    v_cvt_pk_bf16_f32 v28, v20, v21
    v_lshlrev_b32 v20, 16, v28
    v_and_b32 v21, 0xffff0000, v28
    v_cvt_pk_bf16_f32 v28, v22, v23
    v_lshlrev_b32 v22, 16, v28
    v_and_b32 v23, 0xffff0000, v28
    v_pk_mul_f32 v[16:17], v[16:17], v[26:27] op_sel_hi:[1,0]
    v_pk_mul_f32 v[18:19], v[18:19], v[26:27] op_sel_hi:[1,0]
    v_pk_mul_f32 v[20:21], v[20:21], v[26:27] op_sel_hi:[1,0]
    v_pk_mul_f32 v[22:23], v[22:23], v[26:27] op_sel_hi:[1,0]
    v_cvt_pk_bf16_f32 v28, v16, v17
    v_lshlrev_b32 v16, 16, v28
    v_and_b32 v17, 0xffff0000, v28
    v_cvt_pk_bf16_f32 v28, v18, v19
    v_lshlrev_b32 v18, 16, v28
    v_and_b32 v19, 0xffff0000, v28
    v_cvt_pk_bf16_f32 v28, v20, v21
    v_lshlrev_b32 v20, 16, v28
    v_and_b32 v21, 0xffff0000, v28
    v_cvt_pk_bf16_f32 v28, v22, v23
    v_lshlrev_b32 v22, 16, v28
    v_and_b32 v23, 0xffff0000, v28
    v_pk_mul_f32 v[16:17], v[16:17], v[56:57]
    v_pk_mul_f32 v[18:19], v[18:19], v[58:59]
    v_pk_mul_f32 v[20:21], v[20:21], v[60:61]
    v_pk_mul_f32 v[22:23], v[22:23], v[62:63]
    v_cvt_pk_bf16_f32 v24, v16, v17
    v_lshlrev_b32 v16, 16, v24
    v_and_b32 v17, 0xffff0000, v24
    v_cvt_pk_bf16_f32 v24, v18, v19
    v_lshlrev_b32 v18, 16, v24
    v_and_b32 v19, 0xffff0000, v24
    v_cvt_pk_bf16_f32 v24, v20, v21
    v_lshlrev_b32 v20, 16, v24
    v_and_b32 v21, 0xffff0000, v24
    v_cvt_pk_bf16_f32 v24, v22, v23
    v_lshlrev_b32 v22, 16, v24
    v_and_b32 v23, 0xffff0000, v24
    v_pk_add_f32 v[16:17], v[16:17], v[48:49]
    v_pk_add_f32 v[18:19], v[18:19], v[50:51]
    v_pk_add_f32 v[20:21], v[20:21], v[52:53]
    v_pk_add_f32 v[22:23], v[22:23], v[54:55]
    v_cvt_pk_bf16_f32 v8, v16, v17
    v_cvt_pk_bf16_f32 v9, v18, v19
    v_cvt_pk_bf16_f32 v10, v20, v21
    v_cvt_pk_bf16_f32 v11, v22, v23
    ds_write_b64 v6, v[8:9]
    ds_write_b64 v6, v[10:11] offset:512
LN_138:
L_T_H2:
    v_and_b32 v5, 3, v1
    v_mul_u32_u24 v6, 1088, v5
    v_lshl_add_u32 v6, v2, 4, v6
    v_add_u32 v6, 131584, v6
    v_lshlrev_b32 v4, 6, v3
    v_lshlrev_b32 v7, 6, v5
    s_cmp_lt_u32 s3, 4
    s_cselect_b32 s65, 1024, 0
    s_cbranch_scc0 GU_143
    v_mov_b32 v4, v7
GU_143:
    v_lshl_add_u32 v4, v2, 4, v4
    s_lshl_b32 s64, s3, 8
    s_add_u32 s64, s64, s65
    s_add_u32 s64, s64, 135936
    v_add_u32 v4, s64, v4
    v_mul_u32_u24 v7, 192, v5
    v_lshl_add_u32 v7, v2, 4, v7
    v_add_u32 v124, 137984, v7
    s_lshr_b32 s64, s3, 1
    s_lshl_b32 s64, s64, 6
    s_and_b32 s65, s3, 1
    s_lshl_b32 s65, s65, 3
    s_add_u32 s64, s64, s65
    s_add_u32 s64, s64, 137984
    v_add_u32 v7, s64, v7
    v_lshlrev_b32 v125, 6, v5
    v_lshl_add_u32 v125, v2, 4, v125
    v_bfe_u32 v8, v1, 2, 1
    v_cmp_eq_u32 s[86:87], 1, v8
    v_mul_u32_u24 v9, 7168, v8
    v_add_u32 v125, v125, v9
    v_bfe_u32 v8, v1, 3, 1
    v_cmp_eq_u32 s[96:97], 0, v8
    s_lshl_b32 s64, s3, 1
    s_mul_i32 s64, s64, 7168
    s_lshl_b32 s65, s6, 8
    s_add_u32 s64, s64, s65
    s_add_u32 s64, s64, 1310720
    v_add_u32 v125, s64, v125
    s_waitcnt lgkmcnt(0)
    s_barrier
    s_cmp_ge_u32 s6, 28
    s_cbranch_scc1 FIN_144
    s_cmp_ge_u32 s3, 8
    s_cbranch_scc1 G_145
    ds_read_b128 v[8:11], v6 offset:0
    ds_read_b128 v[12:15], v6 offset:64
    ds_read_b128 v[16:19], v6 offset:128
    ds_read_b128 v[20:23], v6 offset:192
    ds_read_b128 v[112:115], v6 offset:256
    ds_read_b128 v[116:119], v6 offset:320
    ds_read_b128 v[120:123], v6 offset:384
    ds_read_b128 v[28:31], v6 offset:448
    s_waitcnt lgkmcnt(4)
    v_mfma_f32_16x16x32_bf16 v[24:27], v[32:35], v[8:11], 0
    v_mfma_f32_16x16x32_bf16 v[24:27], v[36:39], v[12:15], v[24:27]
    v_mfma_f32_16x16x32_bf16 v[24:27], v[40:43], v[16:19], v[24:27]
    v_mfma_f32_16x16x32_bf16 v[24:27], v[44:47], v[20:23], v[24:27]
    ds_read_b128 v[8:11], v6 offset:512
    ds_read_b128 v[12:15], v6 offset:576
    ds_read_b128 v[16:19], v6 offset:640
    ds_read_b128 v[20:23], v6 offset:704
    s_waitcnt lgkmcnt(4)
    v_mfma_f32_16x16x32_bf16 v[24:27], v[48:51], v[112:115], v[24:27]
    v_mfma_f32_16x16x32_bf16 v[24:27], v[52:55], v[116:119], v[24:27]
    v_mfma_f32_16x16x32_bf16 v[24:27], v[56:59], v[120:123], v[24:27]
    v_mfma_f32_16x16x32_bf16 v[24:27], v[60:63], v[28:31], v[24:27]
    ds_read_b128 v[112:115], v6 offset:768
    ds_read_b128 v[116:119], v6 offset:832
    ds_read_b128 v[120:123], v6 offset:896
    ds_read_b128 v[28:31], v6 offset:960
    s_waitcnt lgkmcnt(4)
    v_mfma_f32_16x16x32_bf16 v[24:27], v[64:67], v[8:11], v[24:27]
    v_mfma_f32_16x16x32_bf16 v[24:27], v[68:71], v[12:15], v[24:27]
    v_mfma_f32_16x16x32_bf16 v[24:27], v[72:75], v[16:19], v[24:27]
    v_mfma_f32_16x16x32_bf16 v[24:27], v[76:79], v[20:23], v[24:27]
    s_waitcnt lgkmcnt(0)
    v_mfma_f32_16x16x32_bf16 v[24:27], v[80:83], v[112:115], v[24:27]
    v_mfma_f32_16x16x32_bf16 v[24:27], v[84:87], v[116:119], v[24:27]
    v_mfma_f32_16x16x32_bf16 v[24:27], v[88:91], v[120:123], v[24:27]
    v_mfma_f32_16x16x32_bf16 v[24:27], v[92:95], v[28:31], v[24:27]
    s_nop 7
    v_cvt_pk_bf16_f32 v28, v24, v25
    v_lshlrev_b32 v24, 16, v28
    v_and_b32 v25, 0xffff0000, v28
    v_cvt_pk_bf16_f32 v29, v26, v27
    v_lshlrev_b32 v26, 16, v29
    v_and_b32 v27, 0xffff0000, v29
    s_cmp_ge_u32 s3, 4
    s_cbranch_scc1 UPW_146
    v_mul_f32 v16, 0xbfb8aa3b, v24
    v_mul_f32 v17, 0xbfb8aa3b, v25
    v_mul_f32 v18, 0xbfb8aa3b, v26
    v_mul_f32 v19, 0xbfb8aa3b, v27
    v_exp_f32 v16, v16
    v_exp_f32 v17, v17
    v_exp_f32 v18, v18
    v_exp_f32 v19, v19
    s_nop 0
    v_add_f32 v16, 1.0, v16
    v_add_f32 v17, 1.0, v17
    v_add_f32 v18, 1.0, v18
    v_add_f32 v19, 1.0, v19
    v_rcp_f32 v16, v16
    v_rcp_f32 v17, v17
    v_rcp_f32 v18, v18
    v_rcp_f32 v19, v19
    s_nop 0
    v_pk_mul_f32 v[24:25], v[24:25], v[16:17]
    v_pk_mul_f32 v[26:27], v[26:27], v[18:19]
    v_cvt_pk_bf16_f32 v28, v24, v25
    v_lshlrev_b32 v24, 16, v28
    v_and_b32 v25, 0xffff0000, v28
    v_cvt_pk_bf16_f32 v29, v26, v27
    v_lshlrev_b32 v26, 16, v29
    v_and_b32 v27, 0xffff0000, v29
    s_branch G_145
UPW_146:
    v_cmp_gt_u32 vcc, 4, v3
    s_and_saveexec_b64 s[72:73], vcc
    ds_write_b128 v4, v[24:27]
    s_mov_b64 exec, s[72:73]
G_145:
    s_waitcnt lgkmcnt(0)
    s_barrier
    s_cmp_ge_u32 s3, 4
    s_cbranch_scc1 A_147
    ds_read_b128 v[12:15], v4
    v_cmp_gt_u32 vcc, 4, v3
    s_waitcnt lgkmcnt(0)
    v_pk_mul_f32 v[24:25], v[24:25], v[12:13]
    v_pk_mul_f32 v[26:27], v[26:27], v[14:15]
    v_cvt_pk_bf16_f32 v8, v24, v25
    v_cvt_pk_bf16_f32 v9, v26, v27
    s_and_saveexec_b64 s[72:73], vcc
    ds_write_b64 v7, v[8:9]
    s_mov_b64 exec, s[72:73]
A_147:
    v_mov_b32 v29, s4
    v_mov_b32 v31, s4
    s_waitcnt lgkmcnt(0)
    s_barrier
    ds_read_b128 v[8:11], v124
    ds_read_b128 v[12:15], v124 offset:64
    s_waitcnt lgkmcnt(0)
    v_mfma_f32_16x16x32_bf16 v[16:19], v[96:99], v[8:11], 0
    v_mfma_f32_16x16x32_bf16 v[20:23], v[104:107], v[8:11], 0
    v_mfma_f32_16x16x32_bf16 v[16:19], v[100:103], v[12:15], v[16:19]
    v_mfma_f32_16x16x32_bf16 v[20:23], v[108:111], v[12:15], v[20:23]
    s_nop 7
    v_cndmask_b32 v24, v16, v20, s[86:87]
    v_cndmask_b32 v25, v17, v21, s[86:87]
    v_cndmask_b32 v26, v18, v22, s[86:87]
    v_cndmask_b32 v27, v19, v23, s[86:87]
    v_cvt_pk_bf16_f32 v28, v24, v25
    v_cvt_pk_bf16_f32 v30, v26, v27
    s_mov_b64 exec, s[96:97]
    s_cmp_eq_u32 s88, 1
    s_cbranch_scc0 SC_148
    buffer_store_dwordx4 v[28:31], v125, s[8:11], 0 offen
    s_branch SD_149
SC_148:
    buffer_store_dwordx4 v[28:31], v125, s[8:11], 0 offen sc1
SD_149:
    s_mov_b64 exec, -1
FIN_144:
    s_cmp_ge_u32 s3, 7
    s_cbranch_scc1 F2_150
    s_lshl_b32 s64, s3, 8
    v_lshlrev_b32 v127, 4, v3
    v_add_u32 v127, s64, v127
    v_add_u32 v127, 138752, v127
    s_mov_b32 s82, 0
    s_cmp_eq_u32 s88, 1
    s_cbranch_scc0 PS_152
P_153:
    buffer_load_dwordx4 v[8:11], v126, s[8:11], 0 offen offset:0 nt
    s_waitcnt vmcnt(0)
    v_cmp_eq_u32 vcc, s4, v9
    v_cmp_eq_u32 s[72:73], s4, v11
    s_and_b64 vcc, vcc, s[72:73]
    s_cmp_eq_u64 vcc, exec
    s_cbranch_scc1 PD_151
    s_add_u32 s82, s82, 1
    s_cmp_lt_u32 s82, 200000
    s_cbranch_scc1 P_153
    s_branch L_END
PS_152:
P_154:
    buffer_load_dwordx4 v[8:11], v126, s[8:11], 0 offen offset:0 sc1
    s_waitcnt vmcnt(0)
    v_cmp_eq_u32 vcc, s4, v9
    v_cmp_eq_u32 s[72:73], s4, v11
    s_and_b64 vcc, vcc, s[72:73]
    s_cmp_eq_u64 vcc, exec
    s_cbranch_scc1 PD_151
    s_add_u32 s82, s82, 1
    s_cmp_lt_u32 s82, 200000
    s_cbranch_scc1 P_154
    s_branch L_END
PD_151:
    v_lshlrev_b32 v12, 16, v8
    v_and_b32 v13, 0xffff0000, v8
    v_lshlrev_b32 v14, 16, v10
    v_and_b32 v15, 0xffff0000, v10
    v_mov_b32 v16, v12
    v_mov_b32 v17, v13
    v_mov_b32 v18, v14
    v_mov_b32 v19, v15
    s_nop 0
    v_permlane16_swap_b32 v12, v16
    v_permlane16_swap_b32 v13, v17
    v_permlane16_swap_b32 v14, v18
    v_permlane16_swap_b32 v15, v19
    s_nop 0
    v_pk_add_f32 v[12:13], v[12:13], v[16:17]
    v_pk_add_f32 v[14:15], v[14:15], v[18:19]
    v_mov_b32 v16, v12
    v_mov_b32 v17, v13
    v_mov_b32 v18, v14
    v_mov_b32 v19, v15
    s_nop 0
    v_permlane32_swap_b32 v12, v16
    v_permlane32_swap_b32 v13, v17
    v_permlane32_swap_b32 v14, v18
    v_permlane32_swap_b32 v15, v19
    s_nop 0
    v_pk_add_f32 v[12:13], v[12:13], v[16:17]
    v_pk_add_f32 v[14:15], v[14:15], v[18:19]
    s_mov_b64 exec, 0xffff
    ds_write_b128 v127, v[12:15]
    s_mov_b64 exec, -1
F2_150:
    s_waitcnt lgkmcnt(0)
    s_barrier
    s_cmp_lg_u32 s3, 12
    s_cbranch_scc1 L_END
    v_lshlrev_b32 v4, 9, v2
    v_lshl_add_u32 v4, v3, 4, v4
    v_add_u32 v4, 138752, v4
    ds_read_b128 v[8:11], v4 offset:0
    ds_read_b128 v[12:15], v4 offset:256
    v_mov_b32 v30, 0
    v_lshrrev_b32 v4, 2, v1
    v_lshlrev_b32 v4, 10, v4
    v_and_b32 v5, 3, v1
    v_lshl_add_u32 v4, v5, 3, v4
    s_lshl_b32 s64, s6, 5
    s_waitcnt lgkmcnt(0)
    v_cmp_eq_u32 vcc, 3, v2
    s_nop 1
    v_cndmask_b32 v12, v12, v30, vcc
    v_cndmask_b32 v13, v13, v30, vcc
    v_cndmask_b32 v14, v14, v30, vcc
    v_cndmask_b32 v15, v15, v30, vcc
    v_pk_add_f32 v[8:9], v[8:9], v[12:13]
    v_pk_add_f32 v[10:11], v[10:11], v[14:15]
    v_mov_b32 v12, v8
    v_mov_b32 v13, v9
    v_mov_b32 v14, v10
    v_mov_b32 v15, v11
    s_nop 0
    v_permlane16_swap_b32 v8, v12
    v_permlane16_swap_b32 v9, v13
    v_permlane16_swap_b32 v10, v14
    v_permlane16_swap_b32 v11, v15
    s_nop 0
    v_pk_add_f32 v[8:9], v[8:9], v[12:13]
    v_pk_add_f32 v[10:11], v[10:11], v[14:15]
    v_mov_b32 v12, v8
    v_mov_b32 v13, v9
    v_mov_b32 v14, v10
    v_mov_b32 v15, v11
    s_nop 0
    v_permlane32_swap_b32 v8, v12
    v_permlane32_swap_b32 v9, v13
    v_permlane32_swap_b32 v10, v14
    v_permlane32_swap_b32 v11, v15
    s_nop 0
    v_pk_add_f32 v[8:9], v[8:9], v[12:13]
    v_pk_add_f32 v[10:11], v[10:11], v[14:15]
    v_cvt_pk_bf16_f32 v12, v8, v9
    v_lshlrev_b32 v8, 16, v12
    v_and_b32 v9, 0xffff0000, v12
    v_cvt_pk_bf16_f32 v13, v10, v11
    v_lshlrev_b32 v10, 16, v13
    v_and_b32 v11, 0xffff0000, v13
    v_pk_mul_f32 v[8:9], v[52:53], v[8:9]
    v_pk_mul_f32 v[10:11], v[54:55], v[10:11]
    v_cvt_pk_bf16_f32 v12, v8, v9
    v_lshlrev_b32 v8, 16, v12
    v_and_b32 v9, 0xffff0000, v12
    v_cvt_pk_bf16_f32 v13, v10, v11
    v_lshlrev_b32 v10, 16, v13
    v_and_b32 v11, 0xffff0000, v13
    v_pk_add_f32 v[8:9], v[60:61], v[8:9]
    v_pk_add_f32 v[10:11], v[62:63], v[10:11]
    v_cvt_pk_bf16_f32 v16, v8, v9
    v_cvt_pk_bf16_f32 v17, v10, v11
    s_mov_b64 exec, 0xffff
    buffer_store_dwordx2 v[16:17], v4, s[24:27], s64 offen
    s_cmp_lg_u32 s6, 0
    s_cbranch_scc1 EP_155
    s_mov_b64 exec, 1
    v_mov_b32 v8, s4
    s_mov_b32 s64, 0
    buffer_store_dword v8, off, s[8:11], s64 sc1
EP_155:
L_END:
L_EXIT:
    s_endpgm
.section .rodata,"a"
.p2align 6
.amdhsa_kernel adaLN_cond__sliding_block_cached__swiglu_ffn__decode_kernel
  .amdhsa_next_free_vgpr 128
  .amdhsa_next_free_sgpr 102
  .amdhsa_accum_offset 128
  .amdhsa_group_segment_fixed_size 0
  .amdhsa_kernarg_size 112
  .amdhsa_user_sgpr_count 2
  .amdhsa_user_sgpr_kernarg_segment_ptr 1
  .amdhsa_system_sgpr_workgroup_id_x 1
  .amdhsa_float_denorm_mode_32 3
.end_amdhsa_kernel
```
